```python
import torch

def _softmax(x, axis=-1):
    return torch.softmax(x, dim=axis)
def _gelu(x):
    return torch.nn.functional.gelu(x, approximate="tanh")
def _silu(x):
    return torch.nn.functional.silu(x)
def _sigmoid(x):
    return torch.sigmoid(x)
def _layernorm(x, axis=-1, eps=1e-5):
    m = x.mean(dim=axis, keepdim=True)
    v = x.var(dim=axis, keepdim=True, unbiased=False)
    return (x - m) / torch.sqrt(v + eps)
def _scatter_add(tgt, idx, src, axis=0):
    return tgt.clone().index_add_(axis, idx, src)
def _segment_sum(src, seg, n):
    out = torch.zeros((n,) + src.shape[1:], dtype=src.dtype)
    return out.index_add_(0, seg, src)
def _pad(x, pw):
    flat = tuple(v for pair in reversed(pw) for v in pair)
    return torch.nn.functional.pad(x, flat)

kernel_name = 'recurrent_scan__gqa_block_cached__dense_activation_squared_relu__decode'

def setup_inputs():

    _w = (lambda a: (lambda t: t.to(torch.bfloat16) if t.is_floating_point() else t)(torch.as_tensor(a)))
    def _A_setup():
        B, Sq, D = 4, 1, 512
        Hq, Hkv, Sk, Dh = 32, 8, 16384, 128
        assert Hq % Hkv == 0, (Hq, Hkv)
        return {
            "x": _w((lambda *s: torch.randn(*s, dtype=torch.bfloat16) * 0.05)(B, Sq, D)),
            "k_cache": _w((lambda *s: torch.randn(*s, dtype=torch.bfloat16) * 1.6)(B, Hkv, Sk, Dh)),
            "v_cache": _w((lambda *s: torch.randn(*s, dtype=torch.bfloat16) * 0.2)(B, Hkv, Sk, Dh)),
            "wq": _w((lambda *s: torch.randn(*s, dtype=torch.bfloat16) * 1.6)(D, Hq * Dh) * (D ** -0.5)),
            "wo": _w((lambda *s: torch.randn(*s, dtype=torch.bfloat16) * 0.2)(Hq * Dh, D) * ((Hq * Dh) ** -0.5)),
        }
    _A_in = _A_setup()

    def _B_setup():
        B, S, D, F = 4, 1, 512, 1792
        return {
            "x": _w((lambda *s: torch.randn(*s, dtype=torch.bfloat16) * 0.05)(B, S, D)),
            "w1": _w((lambda *s: torch.randn(*s, dtype=torch.bfloat16) * 0.1)(D, F)),
            "b1": _w((lambda *s: torch.randn(*s, dtype=torch.bfloat16) * 0.1)(F)),
            "w2": _w((lambda *s: torch.randn(*s, dtype=torch.bfloat16) * 0.1)(F, D)),
            "b2": _w((lambda *s: torch.randn(*s, dtype=torch.bfloat16) * 0.1)(D)),
        }
    _B_in = _B_setup()

    return {
        "A_x": _A_in["x"],
        "A_k_cache": _A_in["k_cache"],
        "A_v_cache": _A_in["v_cache"],
        "A_wq": _A_in["wq"],
        "A_wo": _A_in["wo"],
        "B_x": _B_in["x"],
        "B_w1": _B_in["w1"],
        "B_b1": _B_in["b1"],
        "B_w2": _B_in["w2"],
        "B_b2": _B_in["b2"],
    }

def reference(A_x, A_k_cache, A_v_cache, A_wq, A_wo, B_x, B_w1, B_b1, B_w2, B_b2):
    def _A_ref(x, k_cache, v_cache, wq, wo):
        B, Sq, D = x.shape
        Hq, Dh = 32, 128
        Hkv = k_cache.shape[1]
        rep = Hq // Hkv
        q = (lambda x, *d: x.permute(*d))((x @ wq).reshape(B, Sq, Hq, Dh), 0, 2, 1, 3)
        k = (lambda x, n, axis: torch.repeat_interleave(x, n, dim=axis))(k_cache, rep, axis=1)
        v = (lambda x, n, axis: torch.repeat_interleave(x, n, dim=axis))(v_cache, rep, axis=1)
        scores = torch.einsum("bhqd,bhkd->bhqk", q, k) * (Dh ** -0.5)
        p = _softmax(scores, axis=-1)
        o = torch.einsum("bhqk,bhkd->bhqd", p, v)
        return (lambda x, *d: x.permute(*d))(o, 0, 2, 1, 3).reshape(B, Sq, Hq * Dh) @ wo

    def _B_ref(x, w1, b1, w2, b2):
        h = torch.einsum("bsd,df->bsf", x, w1) + b1
        zero = torch.zeros_like(h)
        r = torch.where(h > zero, h, zero)
        h = r * r
        out = torch.einsum("bsf,fd->bsd", h, w2) + b2
        return out

    x = A_x
    xn = _layernorm(x, axis=-1)
    s = _A_ref(xn, A_k_cache, A_v_cache, A_wq, A_wo)
    g = _silu(_B_ref(xn, B_w1, B_b1, B_w2, B_b2))
    return x + s * g
```

```asm
; @launch grid=(256,1,1) block=(320,1,1) lds=61440
.amdgcn_target "amdgcn-amd-amdhsa--gfx950"
.text
.globl recurrent_scan__gqa_block_cached__dense_activation_squared_relu__decode_kernel
.p2align 8
.type recurrent_scan__gqa_block_cached__dense_activation_squared_relu__decode_kernel,@function
recurrent_scan__gqa_block_cached__dense_activation_squared_relu__decode_kernel:
  s_cmp_ge_u32 s2, 256
  s_cbranch_scc1 L_end
  s_load_dwordx2 s[28:29], s[0:1], 0
  s_load_dwordx2 s[32:33], s[0:1], 24
  s_load_dwordx2 s[16:17], s[0:1], 96
  s_load_dwordx2 s[8:9], s[0:1], 8
  s_mov_b32 s18, 0x400000
  s_mov_b32 s19, 0x20000
  v_lshrrev_b32 v1, 6, v0
  v_and_b32 v0, 63, v0
  s_lshr_b32 s4, s2, 6
  v_readfirstlane_b32 s3, v1
  s_and_b32 s5, s2, 7
  s_bfe_u32 s6, s2, 0x30003
  s_mov_b32 s73, 0xffff0000
  s_cmp_eq_u32 s3, 0
  s_cbranch_scc1 L_helper
  s_mov_b32 s10, 0x400000
  s_mov_b32 s11, 0x20000
  s_sub_u32 s74, s3, 1
  s_lshl_b32 s52, s4, 3
  s_add_u32 s52, s52, s5
  s_lshl_b32 s52, s52, 22
  s_bfe_u32 s39, s6, 0x10000
  s_lshl_b32 s39, s39, 16
  s_bfe_u32 s64, s6, 0x20001
  s_lshl_b32 s64, s64, 20
  s_or_b32 s39, s39, s64
  s_bfe_u32 s64, s74, 0x10000
  s_lshl_b32 s64, s64, 12
  s_or_b32 s60, s39, s64
  s_bfe_u32 s64, s74, 0x10001
  s_lshl_b32 s64, s64, 14
  s_or_b32 s60, s60, s64
  v_bfe_u32 v1, v0, 1, 1
  v_lshlrev_b32 v1, 10, v1
  v_bfe_u32 v6, v0, 2, 2
  v_lshl_add_u32 v1, v6, 8, v1
  v_lshrrev_b32 v7, 4, v0
  v_lshl_add_u32 v1, v7, 5, v1
  v_and_b32 v6, 1, v0
  v_lshl_add_u32 v1, v6, 4, v1
  s_waitcnt lgkmcnt(0)
  s_add_u32 s8, s8, s52
  s_addc_u32 s9, s9, 0
  s_barrier
  buffer_load_dwordx2 v[64:65], v1, s[8:11], s60 offen offset:0 nt
  buffer_load_dwordx2 v[66:67], v1, s[8:11], s60 offen offset:8 nt
  buffer_load_dwordx2 v[68:69], v1, s[8:11], s60 offen offset:128 nt
  buffer_load_dwordx2 v[70:71], v1, s[8:11], s60 offen offset:136 nt
  buffer_load_dwordx4 v[72:75], v1, s[8:11], s60 offen offset:2048 nt
  buffer_load_dwordx4 v[76:79], v1, s[8:11], s60 offen offset:2176 nt
  s_waitcnt vmcnt(11)
  s_add_u32 s60, s60, 0x2000
  buffer_load_dwordx2 v[80:81], v1, s[8:11], s60 offen offset:0 nt
  buffer_load_dwordx2 v[82:83], v1, s[8:11], s60 offen offset:8 nt
  buffer_load_dwordx4 v[84:87], v1, s[8:11], s60 offen offset:128 nt
  buffer_load_dwordx4 v[88:91], v1, s[8:11], s60 offen offset:2048 nt
  buffer_load_dwordx4 v[92:95], v1, s[8:11], s60 offen offset:2176 nt
  s_waitcnt vmcnt(11)
  s_add_u32 s60, s60, 0x6000
  buffer_load_dwordx2 v[96:97], v1, s[8:11], s60 offen offset:0 nt
  buffer_load_dwordx2 v[98:99], v1, s[8:11], s60 offen offset:8 nt
  buffer_load_dwordx2 v[100:101], v1, s[8:11], s60 offen offset:128 nt
  buffer_load_dwordx2 v[102:103], v1, s[8:11], s60 offen offset:136 nt
  buffer_load_dwordx4 v[104:107], v1, s[8:11], s60 offen offset:2048 nt
  buffer_load_dwordx4 v[108:111], v1, s[8:11], s60 offen offset:2176 nt
  s_waitcnt vmcnt(11)
  s_add_u32 s60, s60, 0x2000
  buffer_load_dwordx2 v[112:113], v1, s[8:11], s60 offen offset:0 nt
  buffer_load_dwordx2 v[114:115], v1, s[8:11], s60 offen offset:8 nt
  buffer_load_dwordx4 v[116:119], v1, s[8:11], s60 offen offset:128 nt
  buffer_load_dwordx4 v[120:123], v1, s[8:11], s60 offen offset:2048 nt
  buffer_load_dwordx4 v[124:127], v1, s[8:11], s60 offen offset:2176 nt
  s_waitcnt vmcnt(11)
  s_load_dwordx2 s[12:13], s[0:1], 16
  s_load_dwordx2 s[20:21], s[0:1], 32
  s_mov_b32 s14, 0x400000
  s_mov_b32 s15, 0x20000
  s_mov_b32 s22, 0x400000
  s_mov_b32 s23, 0x20000
  v_lshlrev_b32 v2, 4, v0
  s_mov_b32 s56, 0x05040100
  s_mov_b32 s57, 0x07060302
  s_mov_b32 s59, 0x3fb8aa3b
  s_mov_b32 s58, 0x3db504f3
  s_mov_b32 s62, 0
  s_mov_b32 s55, 0
  s_add_u32 s30, s74, 32
  s_add_u32 s33, s74, 0
  s_add_u32 s34, s74, 4
  s_add_u32 s35, s74, 8
  s_mov_b32 s68, 0x000f000f
  s_mov_b32 s69, 0x000f000f
  v_and_b32 v4, 3, v0
  v_lshlrev_b32 v16, 8, v4
  v_lshl_add_u32 v16, v7, 5, v16
  v_bfe_u32 v6, v0, 2, 1
  v_lshl_add_u32 v16, v6, 4, v16
  v_lshlrev_b32 v3, 6, v7
  v_lshl_add_u32 v3, v4, 4, v3
  v_lshlrev_b32 v4, 2, v4
  v_mov_b32 v6, 0
  v_mov_b32 v7, 1
  s_lshl_b32 s28, s5, 2
  s_add_u32 s28, s28, s4
  s_lshl_b32 s28, s28, 6
  s_add_u32 s28, s28, s74
  s_lshl_b32 s28, s28, 11
  s_lshl_b32 s63, s6, 7
  s_add_u32 s28, s28, s63
  s_add_u32 s29, s28, 63488
  s_lshl_b32 s63, s74, 12
  s_add_u32 m0, s63, 45056
  s_lshl_b32 s36, s2, 2
  s_add_u32 s36, s36, s74
  s_lshl_b32 s38, s36, 8
  s_add_u32 s38, s38, 0xc0000
  s_lshl_b32 s36, s36, 9
  s_add_u32 s36, s36, 0x100000
  s_lshl_b32 s37, s74, 6
  s_add_u32 s37, s37, s5
  s_lshl_b32 s37, s37, 2
  s_add_u32 s37, s37, s4
  s_lshl_b32 s37, s37, 9
  s_add_u32 s37, s37, 0x100000
  s_bfe_u32 s64, s34, 0x10000
  s_lshl_b32 s64, s64, 12
  s_or_b32 s60, s39, s64
  s_bfe_u32 s64, s34, 0x10001
  s_lshl_b32 s64, s64, 14
  s_or_b32 s60, s60, s64
  s_bfe_u32 s64, s34, 0x30002
  s_lshl_b32 s64, s64, 17
  s_or_b32 s60, s60, s64
  buffer_load_dwordx2 v[128:129], v1, s[8:11], s60 offen offset:0 nt
  buffer_load_dwordx2 v[130:131], v1, s[8:11], s60 offen offset:8 nt
  buffer_load_dwordx2 v[132:133], v1, s[8:11], s60 offen offset:128 nt
  buffer_load_dwordx2 v[134:135], v1, s[8:11], s60 offen offset:136 nt
  buffer_load_dwordx4 v[136:139], v1, s[8:11], s60 offen offset:2048 nt
  buffer_load_dwordx4 v[140:143], v1, s[8:11], s60 offen offset:2176 nt
  s_waitcnt vmcnt(11)
  s_add_u32 s60, s60, 0x2000
  buffer_load_dwordx2 v[144:145], v1, s[8:11], s60 offen offset:0 nt
  buffer_load_dwordx2 v[146:147], v1, s[8:11], s60 offen offset:8 nt
  buffer_load_dwordx4 v[148:151], v1, s[8:11], s60 offen offset:128 nt
  buffer_load_dwordx4 v[152:155], v1, s[8:11], s60 offen offset:2048 nt
  buffer_load_dwordx4 v[156:159], v1, s[8:11], s60 offen offset:2176 nt
  s_waitcnt vmcnt(11)
  s_add_u32 s60, s60, 0x6000
  buffer_load_dwordx2 v[160:161], v1, s[8:11], s60 offen offset:0 nt
  buffer_load_dwordx2 v[162:163], v1, s[8:11], s60 offen offset:8 nt
  buffer_load_dwordx2 v[164:165], v1, s[8:11], s60 offen offset:128 nt
  buffer_load_dwordx2 v[166:167], v1, s[8:11], s60 offen offset:136 nt
  buffer_load_dwordx4 v[168:171], v1, s[8:11], s60 offen offset:2048 nt
  buffer_load_dwordx4 v[172:175], v1, s[8:11], s60 offen offset:2176 nt
  s_waitcnt vmcnt(11)
  s_add_u32 s60, s60, 0x2000
  buffer_load_dwordx2 v[176:177], v1, s[8:11], s60 offen offset:0 nt
  buffer_load_dwordx2 v[178:179], v1, s[8:11], s60 offen offset:8 nt
  buffer_load_dwordx4 v[180:183], v1, s[8:11], s60 offen offset:128 nt
  buffer_load_dwordx4 v[184:187], v1, s[8:11], s60 offen offset:2048 nt
  buffer_load_dwordx4 v[188:191], v1, s[8:11], s60 offen offset:2176 nt
  s_waitcnt vmcnt(11)
  s_bfe_u32 s64, s35, 0x10000
  s_lshl_b32 s64, s64, 12
  s_or_b32 s60, s39, s64
  s_bfe_u32 s64, s35, 0x10001
  s_lshl_b32 s64, s64, 14
  s_or_b32 s60, s60, s64
  s_bfe_u32 s64, s35, 0x30002
  s_lshl_b32 s64, s64, 17
  s_or_b32 s60, s60, s64
  buffer_load_dwordx2 v[192:193], v1, s[8:11], s60 offen offset:0 nt
  buffer_load_dwordx2 v[194:195], v1, s[8:11], s60 offen offset:8 nt
  buffer_load_dwordx2 v[196:197], v1, s[8:11], s60 offen offset:128 nt
  buffer_load_dwordx2 v[198:199], v1, s[8:11], s60 offen offset:136 nt
  buffer_load_dwordx4 v[200:203], v1, s[8:11], s60 offen offset:2048 nt
  buffer_load_dwordx4 v[204:207], v1, s[8:11], s60 offen offset:2176 nt
  s_add_u32 s60, s60, 0x2000
  buffer_load_dwordx2 v[208:209], v1, s[8:11], s60 offen offset:0 nt
  buffer_load_dwordx2 v[210:211], v1, s[8:11], s60 offen offset:8 nt
  buffer_load_dwordx4 v[212:215], v1, s[8:11], s60 offen offset:128 nt
  buffer_load_dwordx4 v[216:219], v1, s[8:11], s60 offen offset:2048 nt
  buffer_load_dwordx4 v[220:223], v1, s[8:11], s60 offen offset:2176 nt
  s_add_u32 s60, s60, 0x6000
  buffer_load_dwordx2 v[224:225], v1, s[8:11], s60 offen offset:0 nt
  buffer_load_dwordx2 v[226:227], v1, s[8:11], s60 offen offset:8 nt
  buffer_load_dwordx2 v[228:229], v1, s[8:11], s60 offen offset:128 nt
  buffer_load_dwordx2 v[230:231], v1, s[8:11], s60 offen offset:136 nt
  buffer_load_dwordx4 v[232:235], v1, s[8:11], s60 offen offset:2048 nt
  buffer_load_dwordx4 v[236:239], v1, s[8:11], s60 offen offset:2176 nt
  s_add_u32 s60, s60, 0x2000
  buffer_load_dwordx2 v[240:241], v1, s[8:11], s60 offen offset:0 nt
  buffer_load_dwordx2 v[242:243], v1, s[8:11], s60 offen offset:8 nt
  buffer_load_dwordx4 v[244:247], v1, s[8:11], s60 offen offset:128 nt
  buffer_load_dwordx4 v[248:251], v1, s[8:11], s60 offen offset:2048 nt
  buffer_load_dwordx4 v[252:255], v1, s[8:11], s60 offen offset:2176 nt
  s_mov_b32 s72, 0
L_wq:
  ds_read_b64 v[18:19], v6 offset:2048
  s_add_u32 s72, s72, 1
  s_waitcnt lgkmcnt(0)
  v_cmp_ne_u32 vcc, 0, v19
  s_cbranch_vccnz L_wq_ok
  s_sleep 2
  s_cmp_lt_u32 s72, 0x400000
  s_cbranch_scc1 L_wq
L_wq_ok:
  s_add_u32 s12, s12, s52
  s_addc_u32 s13, s13, 0
  ds_read_b128 v[8:11], v16 offset:0
  ds_read_b128 v[12:15], v16 offset:128
  v_readfirstlane_b32 s75, v18
  v_readfirstlane_b32 s53, v19
  s_waitcnt lgkmcnt(0)
.p2align 3
L_k0:
  s_cmp_ge_u32 s33, 32
  s_cbranch_scc1 L_tr0
  s_waitcnt vmcnt(44)
  v_mfma_f32_16x16x32_bf16 v[32:35], v[64:67], v[8:11], 0
  v_mfma_f32_16x16x32_bf16 v[32:35], v[68:71], v[12:15], v[32:35]
  v_mfma_f32_16x16x32_bf16 v[36:39], v[72:75], v[8:11], 0
  v_mfma_f32_16x16x32_bf16 v[36:39], v[76:79], v[12:15], v[36:39]
  s_waitcnt vmcnt(40)
  v_mfma_f32_16x16x32_bf16 v[40:43], v[80:83], v[8:11], 0
  v_mfma_f32_16x16x32_bf16 v[40:43], v[84:87], v[12:15], v[40:43]
  v_mfma_f32_16x16x32_bf16 v[44:47], v[88:91], v[8:11], 0
  v_mfma_f32_16x16x32_bf16 v[44:47], v[92:95], v[12:15], v[44:47]
  s_waitcnt vmcnt(36)
  v_mfma_f32_16x16x32_bf16 v[48:51], v[96:99], v[8:11], 0
  v_mfma_f32_16x16x32_bf16 v[48:51], v[100:103], v[12:15], v[48:51]
  v_mfma_f32_16x16x32_bf16 v[52:55], v[104:107], v[8:11], 0
  v_mfma_f32_16x16x32_bf16 v[52:55], v[108:111], v[12:15], v[52:55]
  s_waitcnt vmcnt(32)
  v_mfma_f32_16x16x32_bf16 v[56:59], v[112:115], v[8:11], 0
  v_mfma_f32_16x16x32_bf16 v[56:59], v[116:119], v[12:15], v[56:59]
  v_mfma_f32_16x16x32_bf16 v[60:63], v[120:123], v[8:11], 0
  v_mfma_f32_16x16x32_bf16 v[60:63], v[124:127], v[12:15], v[60:63]
  v_add_f32_dpp v16, v33, v32 row_shl:4 row_mask:0xf bank_mask:0xf bound_ctrl:0
  v_add_f32_dpp v17, v35, v34 row_shl:4 row_mask:0xf bank_mask:0xf bound_ctrl:0
  v_add_f32_dpp v18, v37, v36 row_shl:4 row_mask:0xf bank_mask:0xf bound_ctrl:0
  v_add_f32_dpp v19, v39, v38 row_shl:4 row_mask:0xf bank_mask:0xf bound_ctrl:0
  v_add_f32_dpp v20, v41, v40 row_shl:4 row_mask:0xf bank_mask:0xf bound_ctrl:0
  v_add_f32_dpp v21, v43, v42 row_shl:4 row_mask:0xf bank_mask:0xf bound_ctrl:0
  v_add_f32_dpp v22, v45, v44 row_shl:4 row_mask:0xf bank_mask:0xf bound_ctrl:0
  v_add_f32_dpp v23, v47, v46 row_shl:4 row_mask:0xf bank_mask:0xf bound_ctrl:0
  v_add_f32_dpp v24, v49, v48 row_shl:4 row_mask:0xf bank_mask:0xf bound_ctrl:0
  v_add_f32_dpp v25, v51, v50 row_shl:4 row_mask:0xf bank_mask:0xf bound_ctrl:0
  v_add_f32_dpp v26, v53, v52 row_shl:4 row_mask:0xf bank_mask:0xf bound_ctrl:0
  v_add_f32_dpp v27, v55, v54 row_shl:4 row_mask:0xf bank_mask:0xf bound_ctrl:0
  v_add_f32_dpp v28, v57, v56 row_shl:4 row_mask:0xf bank_mask:0xf bound_ctrl:0
  v_add_f32_dpp v29, v59, v58 row_shl:4 row_mask:0xf bank_mask:0xf bound_ctrl:0
  v_add_f32_dpp v30, v61, v60 row_shl:4 row_mask:0xf bank_mask:0xf bound_ctrl:0
  v_add_f32_dpp v31, v63, v62 row_shl:4 row_mask:0xf bank_mask:0xf bound_ctrl:0
  v_cvt_pk_bf16_f32 v32, v16, v17
  v_cvt_pk_bf16_f32 v33, v18, v19
  v_cvt_pk_bf16_f32 v34, v20, v21
  v_cvt_pk_bf16_f32 v35, v22, v23
  v_cvt_pk_bf16_f32 v36, v24, v25
  v_cvt_pk_bf16_f32 v37, v26, v27
  v_cvt_pk_bf16_f32 v38, v28, v29
  v_cvt_pk_bf16_f32 v39, v30, v31
  v_lshlrev_b32 v16, 16, v32
  v_and_b32 v17, s73, v32
  v_lshlrev_b32 v18, 16, v33
  v_and_b32 v19, s73, v33
  v_lshlrev_b32 v20, 16, v34
  v_and_b32 v21, s73, v34
  v_lshlrev_b32 v22, 16, v35
  v_and_b32 v23, s73, v35
  v_lshlrev_b32 v24, 16, v36
  v_and_b32 v25, s73, v36
  v_lshlrev_b32 v26, 16, v37
  v_and_b32 v27, s73, v37
  v_lshlrev_b32 v28, 16, v38
  v_and_b32 v29, s73, v38
  v_lshlrev_b32 v30, 16, v39
  v_and_b32 v31, s73, v39
  v_mul_f32 v16, s58, v16
  v_mul_f32 v17, s58, v17
  v_mul_f32 v18, s58, v18
  v_mul_f32 v19, s58, v19
  v_mul_f32 v20, s58, v20
  v_mul_f32 v21, s58, v21
  v_mul_f32 v22, s58, v22
  v_mul_f32 v23, s58, v23
  v_mul_f32 v24, s58, v24
  v_mul_f32 v25, s58, v25
  v_mul_f32 v26, s58, v26
  v_mul_f32 v27, s58, v27
  v_mul_f32 v28, s58, v28
  v_mul_f32 v29, s58, v29
  v_mul_f32 v30, s58, v30
  v_mul_f32 v31, s58, v31
  v_cvt_pk_bf16_f32 v40, v16, v17
  v_cvt_pk_bf16_f32 v41, v18, v19
  v_cvt_pk_bf16_f32 v42, v20, v21
  v_cvt_pk_bf16_f32 v43, v22, v23
  v_cvt_pk_bf16_f32 v44, v24, v25
  v_cvt_pk_bf16_f32 v45, v26, v27
  v_cvt_pk_bf16_f32 v46, v28, v29
  v_cvt_pk_bf16_f32 v47, v30, v31
  s_lshl_b32 s63, s33, 9
  v_add_u32 v48, s63, v3
  v_max3_f32 v49, v16, v17, v18
  v_max3_f32 v50, v19, v20, v21
  v_max3_f32 v49, v49, v22, v23
  v_max3_f32 v50, v50, v24, v25
  v_max3_f32 v49, v49, v26, v27
  v_max3_f32 v50, v50, v28, v29
  v_max3_f32 v49, v49, v30, v31
  v_max_f32 v49, v49, v50
  s_mov_b64 exec, s[68:69]
  ds_write_b128 v48, v[40:43] offset:12288
  ds_write_b128 v48, v[44:47] offset:12544
  ds_max_f32 v4, v49 offset:2064
  ds_add_u32 v6, v7 offset:2060
  s_mov_b64 exec, 1
  ds_add_rtn_u32 v16, v6, v7 offset:2056
  ds_read_b32 v17, v6 offset:2128
  s_mov_b64 exec, -1
  s_waitcnt lgkmcnt(0)
  v_readfirstlane_b32 s33, v16
  v_readfirstlane_b32 s54, v17
  s_cmp_ge_u32 s33, 32
  s_cselect_b32 s33, s30, s33
  s_cselect_b32 s64, 4, 0
  s_add_u32 s30, s30, s64
  s_bfe_u32 s64, s33, 0x10000
  s_lshl_b32 s64, s64, 12
  s_or_b32 s60, s39, s64
  s_bfe_u32 s64, s33, 0x10001
  s_lshl_b32 s64, s64, 14
  s_or_b32 s60, s60, s64
  s_bfe_u32 s64, s33, 0x30002
  s_lshl_b32 s64, s64, 17
  s_or_b32 s60, s60, s64
  s_cmp_ge_u32 s33, 32
  s_cbranch_scc1 L_kv0
  s_cmp_ge_u32 s33, s54
  s_cbranch_scc1 L_kb0
  buffer_load_dwordx2 v[64:65], v1, s[8:11], s60 offen offset:0 nt
  buffer_load_dwordx2 v[66:67], v1, s[8:11], s60 offen offset:8 nt
  buffer_load_dwordx2 v[68:69], v1, s[8:11], s60 offen offset:128 nt
  buffer_load_dwordx2 v[70:71], v1, s[8:11], s60 offen offset:136 nt
  buffer_load_dwordx4 v[72:75], v1, s[8:11], s60 offen offset:2048 nt
  buffer_load_dwordx4 v[76:79], v1, s[8:11], s60 offen offset:2176 nt
  s_add_u32 s60, s60, 0x2000
  buffer_load_dwordx2 v[80:81], v1, s[8:11], s60 offen offset:0 nt
  buffer_load_dwordx2 v[82:83], v1, s[8:11], s60 offen offset:8 nt
  buffer_load_dwordx4 v[84:87], v1, s[8:11], s60 offen offset:128 nt
  buffer_load_dwordx4 v[88:91], v1, s[8:11], s60 offen offset:2048 nt
  buffer_load_dwordx4 v[92:95], v1, s[8:11], s60 offen offset:2176 nt
  s_add_u32 s60, s60, 0x6000
  buffer_load_dwordx2 v[96:97], v1, s[8:11], s60 offen offset:0 nt
  buffer_load_dwordx2 v[98:99], v1, s[8:11], s60 offen offset:8 nt
  buffer_load_dwordx2 v[100:101], v1, s[8:11], s60 offen offset:128 nt
  buffer_load_dwordx2 v[102:103], v1, s[8:11], s60 offen offset:136 nt
  buffer_load_dwordx4 v[104:107], v1, s[8:11], s60 offen offset:2048 nt
  buffer_load_dwordx4 v[108:111], v1, s[8:11], s60 offen offset:2176 nt
  s_add_u32 s60, s60, 0x2000
  buffer_load_dwordx2 v[112:113], v1, s[8:11], s60 offen offset:0 nt
  buffer_load_dwordx2 v[114:115], v1, s[8:11], s60 offen offset:8 nt
  buffer_load_dwordx4 v[116:119], v1, s[8:11], s60 offen offset:128 nt
  buffer_load_dwordx4 v[120:123], v1, s[8:11], s60 offen offset:2048 nt
  buffer_load_dwordx4 v[124:127], v1, s[8:11], s60 offen offset:2176 nt
L_k1:
  s_cmp_ge_u32 s34, 32
  s_cbranch_scc1 L_tr1
  s_waitcnt vmcnt(44)
  v_mfma_f32_16x16x32_bf16 v[32:35], v[128:131], v[8:11], 0
  v_mfma_f32_16x16x32_bf16 v[32:35], v[132:135], v[12:15], v[32:35]
  v_mfma_f32_16x16x32_bf16 v[36:39], v[136:139], v[8:11], 0
  v_mfma_f32_16x16x32_bf16 v[36:39], v[140:143], v[12:15], v[36:39]
  s_waitcnt vmcnt(40)
  v_mfma_f32_16x16x32_bf16 v[40:43], v[144:147], v[8:11], 0
  v_mfma_f32_16x16x32_bf16 v[40:43], v[148:151], v[12:15], v[40:43]
  v_mfma_f32_16x16x32_bf16 v[44:47], v[152:155], v[8:11], 0
  v_mfma_f32_16x16x32_bf16 v[44:47], v[156:159], v[12:15], v[44:47]
  s_waitcnt vmcnt(36)
  v_mfma_f32_16x16x32_bf16 v[48:51], v[160:163], v[8:11], 0
  v_mfma_f32_16x16x32_bf16 v[48:51], v[164:167], v[12:15], v[48:51]
  v_mfma_f32_16x16x32_bf16 v[52:55], v[168:171], v[8:11], 0
  v_mfma_f32_16x16x32_bf16 v[52:55], v[172:175], v[12:15], v[52:55]
  s_waitcnt vmcnt(32)
  v_mfma_f32_16x16x32_bf16 v[56:59], v[176:179], v[8:11], 0
  v_mfma_f32_16x16x32_bf16 v[56:59], v[180:183], v[12:15], v[56:59]
  v_mfma_f32_16x16x32_bf16 v[60:63], v[184:187], v[8:11], 0
  v_mfma_f32_16x16x32_bf16 v[60:63], v[188:191], v[12:15], v[60:63]
  v_add_f32_dpp v16, v33, v32 row_shl:4 row_mask:0xf bank_mask:0xf bound_ctrl:0
  v_add_f32_dpp v17, v35, v34 row_shl:4 row_mask:0xf bank_mask:0xf bound_ctrl:0
  v_add_f32_dpp v18, v37, v36 row_shl:4 row_mask:0xf bank_mask:0xf bound_ctrl:0
  v_add_f32_dpp v19, v39, v38 row_shl:4 row_mask:0xf bank_mask:0xf bound_ctrl:0
  v_add_f32_dpp v20, v41, v40 row_shl:4 row_mask:0xf bank_mask:0xf bound_ctrl:0
  v_add_f32_dpp v21, v43, v42 row_shl:4 row_mask:0xf bank_mask:0xf bound_ctrl:0
  v_add_f32_dpp v22, v45, v44 row_shl:4 row_mask:0xf bank_mask:0xf bound_ctrl:0
  v_add_f32_dpp v23, v47, v46 row_shl:4 row_mask:0xf bank_mask:0xf bound_ctrl:0
  v_add_f32_dpp v24, v49, v48 row_shl:4 row_mask:0xf bank_mask:0xf bound_ctrl:0
  v_add_f32_dpp v25, v51, v50 row_shl:4 row_mask:0xf bank_mask:0xf bound_ctrl:0
  v_add_f32_dpp v26, v53, v52 row_shl:4 row_mask:0xf bank_mask:0xf bound_ctrl:0
  v_add_f32_dpp v27, v55, v54 row_shl:4 row_mask:0xf bank_mask:0xf bound_ctrl:0
  v_add_f32_dpp v28, v57, v56 row_shl:4 row_mask:0xf bank_mask:0xf bound_ctrl:0
  v_add_f32_dpp v29, v59, v58 row_shl:4 row_mask:0xf bank_mask:0xf bound_ctrl:0
  v_add_f32_dpp v30, v61, v60 row_shl:4 row_mask:0xf bank_mask:0xf bound_ctrl:0
  v_add_f32_dpp v31, v63, v62 row_shl:4 row_mask:0xf bank_mask:0xf bound_ctrl:0
  v_cvt_pk_bf16_f32 v32, v16, v17
  v_cvt_pk_bf16_f32 v33, v18, v19
  v_cvt_pk_bf16_f32 v34, v20, v21
  v_cvt_pk_bf16_f32 v35, v22, v23
  v_cvt_pk_bf16_f32 v36, v24, v25
  v_cvt_pk_bf16_f32 v37, v26, v27
  v_cvt_pk_bf16_f32 v38, v28, v29
  v_cvt_pk_bf16_f32 v39, v30, v31
  v_lshlrev_b32 v16, 16, v32
  v_and_b32 v17, s73, v32
  v_lshlrev_b32 v18, 16, v33
  v_and_b32 v19, s73, v33
  v_lshlrev_b32 v20, 16, v34
  v_and_b32 v21, s73, v34
  v_lshlrev_b32 v22, 16, v35
  v_and_b32 v23, s73, v35
  v_lshlrev_b32 v24, 16, v36
  v_and_b32 v25, s73, v36
  v_lshlrev_b32 v26, 16, v37
  v_and_b32 v27, s73, v37
  v_lshlrev_b32 v28, 16, v38
  v_and_b32 v29, s73, v38
  v_lshlrev_b32 v30, 16, v39
  v_and_b32 v31, s73, v39
  v_mul_f32 v16, s58, v16
  v_mul_f32 v17, s58, v17
  v_mul_f32 v18, s58, v18
  v_mul_f32 v19, s58, v19
  v_mul_f32 v20, s58, v20
  v_mul_f32 v21, s58, v21
  v_mul_f32 v22, s58, v22
  v_mul_f32 v23, s58, v23
  v_mul_f32 v24, s58, v24
  v_mul_f32 v25, s58, v25
  v_mul_f32 v26, s58, v26
  v_mul_f32 v27, s58, v27
  v_mul_f32 v28, s58, v28
  v_mul_f32 v29, s58, v29
  v_mul_f32 v30, s58, v30
  v_mul_f32 v31, s58, v31
  v_cvt_pk_bf16_f32 v40, v16, v17
  v_cvt_pk_bf16_f32 v41, v18, v19
  v_cvt_pk_bf16_f32 v42, v20, v21
  v_cvt_pk_bf16_f32 v43, v22, v23
  v_cvt_pk_bf16_f32 v44, v24, v25
  v_cvt_pk_bf16_f32 v45, v26, v27
  v_cvt_pk_bf16_f32 v46, v28, v29
  v_cvt_pk_bf16_f32 v47, v30, v31
  s_lshl_b32 s63, s34, 9
  v_add_u32 v48, s63, v3
  v_max3_f32 v49, v16, v17, v18
  v_max3_f32 v50, v19, v20, v21
  v_max3_f32 v49, v49, v22, v23
  v_max3_f32 v50, v50, v24, v25
  v_max3_f32 v49, v49, v26, v27
  v_max3_f32 v50, v50, v28, v29
  v_max3_f32 v49, v49, v30, v31
  v_max_f32 v49, v49, v50
  s_mov_b64 exec, s[68:69]
  ds_write_b128 v48, v[40:43] offset:12288
  ds_write_b128 v48, v[44:47] offset:12544
  ds_max_f32 v4, v49 offset:2064
  ds_add_u32 v6, v7 offset:2060
  s_mov_b64 exec, 1
  ds_add_rtn_u32 v16, v6, v7 offset:2056
  ds_read_b32 v17, v6 offset:2128
  s_mov_b64 exec, -1
  s_waitcnt lgkmcnt(0)
  v_readfirstlane_b32 s34, v16
  v_readfirstlane_b32 s54, v17
  s_cmp_ge_u32 s34, 32
  s_cselect_b32 s34, s30, s34
  s_cselect_b32 s64, 4, 0
  s_add_u32 s30, s30, s64
  s_bfe_u32 s64, s34, 0x10000
  s_lshl_b32 s64, s64, 12
  s_or_b32 s60, s39, s64
  s_bfe_u32 s64, s34, 0x10001
  s_lshl_b32 s64, s64, 14
  s_or_b32 s60, s60, s64
  s_bfe_u32 s64, s34, 0x30002
  s_lshl_b32 s64, s64, 17
  s_or_b32 s60, s60, s64
  s_cmp_ge_u32 s34, 32
  s_cbranch_scc1 L_kv1
  s_cmp_ge_u32 s34, s54
  s_cbranch_scc1 L_kb1
  buffer_load_dwordx2 v[128:129], v1, s[8:11], s60 offen offset:0 nt
  buffer_load_dwordx2 v[130:131], v1, s[8:11], s60 offen offset:8 nt
  buffer_load_dwordx2 v[132:133], v1, s[8:11], s60 offen offset:128 nt
  buffer_load_dwordx2 v[134:135], v1, s[8:11], s60 offen offset:136 nt
  buffer_load_dwordx4 v[136:139], v1, s[8:11], s60 offen offset:2048 nt
  buffer_load_dwordx4 v[140:143], v1, s[8:11], s60 offen offset:2176 nt
  s_add_u32 s60, s60, 0x2000
  buffer_load_dwordx2 v[144:145], v1, s[8:11], s60 offen offset:0 nt
  buffer_load_dwordx2 v[146:147], v1, s[8:11], s60 offen offset:8 nt
  buffer_load_dwordx4 v[148:151], v1, s[8:11], s60 offen offset:128 nt
  buffer_load_dwordx4 v[152:155], v1, s[8:11], s60 offen offset:2048 nt
  buffer_load_dwordx4 v[156:159], v1, s[8:11], s60 offen offset:2176 nt
  s_add_u32 s60, s60, 0x6000
  buffer_load_dwordx2 v[160:161], v1, s[8:11], s60 offen offset:0 nt
  buffer_load_dwordx2 v[162:163], v1, s[8:11], s60 offen offset:8 nt
  buffer_load_dwordx2 v[164:165], v1, s[8:11], s60 offen offset:128 nt
  buffer_load_dwordx2 v[166:167], v1, s[8:11], s60 offen offset:136 nt
  buffer_load_dwordx4 v[168:171], v1, s[8:11], s60 offen offset:2048 nt
  buffer_load_dwordx4 v[172:175], v1, s[8:11], s60 offen offset:2176 nt
  s_add_u32 s60, s60, 0x2000
  buffer_load_dwordx2 v[176:177], v1, s[8:11], s60 offen offset:0 nt
  buffer_load_dwordx2 v[178:179], v1, s[8:11], s60 offen offset:8 nt
  buffer_load_dwordx4 v[180:183], v1, s[8:11], s60 offen offset:128 nt
  buffer_load_dwordx4 v[184:187], v1, s[8:11], s60 offen offset:2048 nt
  buffer_load_dwordx4 v[188:191], v1, s[8:11], s60 offen offset:2176 nt
L_k2:
  s_cmp_ge_u32 s35, 32
  s_cbranch_scc1 L_tr2
  s_waitcnt vmcnt(44)
  v_mfma_f32_16x16x32_bf16 v[32:35], v[192:195], v[8:11], 0
  v_mfma_f32_16x16x32_bf16 v[32:35], v[196:199], v[12:15], v[32:35]
  v_mfma_f32_16x16x32_bf16 v[36:39], v[200:203], v[8:11], 0
  v_mfma_f32_16x16x32_bf16 v[36:39], v[204:207], v[12:15], v[36:39]
  s_waitcnt vmcnt(40)
  v_mfma_f32_16x16x32_bf16 v[40:43], v[208:211], v[8:11], 0
  v_mfma_f32_16x16x32_bf16 v[40:43], v[212:215], v[12:15], v[40:43]
  v_mfma_f32_16x16x32_bf16 v[44:47], v[216:219], v[8:11], 0
  v_mfma_f32_16x16x32_bf16 v[44:47], v[220:223], v[12:15], v[44:47]
  s_waitcnt vmcnt(36)
  v_mfma_f32_16x16x32_bf16 v[48:51], v[224:227], v[8:11], 0
  v_mfma_f32_16x16x32_bf16 v[48:51], v[228:231], v[12:15], v[48:51]
  v_mfma_f32_16x16x32_bf16 v[52:55], v[232:235], v[8:11], 0
  v_mfma_f32_16x16x32_bf16 v[52:55], v[236:239], v[12:15], v[52:55]
  s_waitcnt vmcnt(32)
  v_mfma_f32_16x16x32_bf16 v[56:59], v[240:243], v[8:11], 0
  v_mfma_f32_16x16x32_bf16 v[56:59], v[244:247], v[12:15], v[56:59]
  v_mfma_f32_16x16x32_bf16 v[60:63], v[248:251], v[8:11], 0
  v_mfma_f32_16x16x32_bf16 v[60:63], v[252:255], v[12:15], v[60:63]
  v_add_f32_dpp v16, v33, v32 row_shl:4 row_mask:0xf bank_mask:0xf bound_ctrl:0
  v_add_f32_dpp v17, v35, v34 row_shl:4 row_mask:0xf bank_mask:0xf bound_ctrl:0
  v_add_f32_dpp v18, v37, v36 row_shl:4 row_mask:0xf bank_mask:0xf bound_ctrl:0
  v_add_f32_dpp v19, v39, v38 row_shl:4 row_mask:0xf bank_mask:0xf bound_ctrl:0
  v_add_f32_dpp v20, v41, v40 row_shl:4 row_mask:0xf bank_mask:0xf bound_ctrl:0
  v_add_f32_dpp v21, v43, v42 row_shl:4 row_mask:0xf bank_mask:0xf bound_ctrl:0
  v_add_f32_dpp v22, v45, v44 row_shl:4 row_mask:0xf bank_mask:0xf bound_ctrl:0
  v_add_f32_dpp v23, v47, v46 row_shl:4 row_mask:0xf bank_mask:0xf bound_ctrl:0
  v_add_f32_dpp v24, v49, v48 row_shl:4 row_mask:0xf bank_mask:0xf bound_ctrl:0
  v_add_f32_dpp v25, v51, v50 row_shl:4 row_mask:0xf bank_mask:0xf bound_ctrl:0
  v_add_f32_dpp v26, v53, v52 row_shl:4 row_mask:0xf bank_mask:0xf bound_ctrl:0
  v_add_f32_dpp v27, v55, v54 row_shl:4 row_mask:0xf bank_mask:0xf bound_ctrl:0
  v_add_f32_dpp v28, v57, v56 row_shl:4 row_mask:0xf bank_mask:0xf bound_ctrl:0
  v_add_f32_dpp v29, v59, v58 row_shl:4 row_mask:0xf bank_mask:0xf bound_ctrl:0
  v_add_f32_dpp v30, v61, v60 row_shl:4 row_mask:0xf bank_mask:0xf bound_ctrl:0
  v_add_f32_dpp v31, v63, v62 row_shl:4 row_mask:0xf bank_mask:0xf bound_ctrl:0
  v_cvt_pk_bf16_f32 v32, v16, v17
  v_cvt_pk_bf16_f32 v33, v18, v19
  v_cvt_pk_bf16_f32 v34, v20, v21
  v_cvt_pk_bf16_f32 v35, v22, v23
  v_cvt_pk_bf16_f32 v36, v24, v25
  v_cvt_pk_bf16_f32 v37, v26, v27
  v_cvt_pk_bf16_f32 v38, v28, v29
  v_cvt_pk_bf16_f32 v39, v30, v31
  v_lshlrev_b32 v16, 16, v32
  v_and_b32 v17, s73, v32
  v_lshlrev_b32 v18, 16, v33
  v_and_b32 v19, s73, v33
  v_lshlrev_b32 v20, 16, v34
  v_and_b32 v21, s73, v34
  v_lshlrev_b32 v22, 16, v35
  v_and_b32 v23, s73, v35
  v_lshlrev_b32 v24, 16, v36
  v_and_b32 v25, s73, v36
  v_lshlrev_b32 v26, 16, v37
  v_and_b32 v27, s73, v37
  v_lshlrev_b32 v28, 16, v38
  v_and_b32 v29, s73, v38
  v_lshlrev_b32 v30, 16, v39
  v_and_b32 v31, s73, v39
  v_mul_f32 v16, s58, v16
  v_mul_f32 v17, s58, v17
  v_mul_f32 v18, s58, v18
  v_mul_f32 v19, s58, v19
  v_mul_f32 v20, s58, v20
  v_mul_f32 v21, s58, v21
  v_mul_f32 v22, s58, v22
  v_mul_f32 v23, s58, v23
  v_mul_f32 v24, s58, v24
  v_mul_f32 v25, s58, v25
  v_mul_f32 v26, s58, v26
  v_mul_f32 v27, s58, v27
  v_mul_f32 v28, s58, v28
  v_mul_f32 v29, s58, v29
  v_mul_f32 v30, s58, v30
  v_mul_f32 v31, s58, v31
  v_cvt_pk_bf16_f32 v40, v16, v17
  v_cvt_pk_bf16_f32 v41, v18, v19
  v_cvt_pk_bf16_f32 v42, v20, v21
  v_cvt_pk_bf16_f32 v43, v22, v23
  v_cvt_pk_bf16_f32 v44, v24, v25
  v_cvt_pk_bf16_f32 v45, v26, v27
  v_cvt_pk_bf16_f32 v46, v28, v29
  v_cvt_pk_bf16_f32 v47, v30, v31
  s_lshl_b32 s63, s35, 9
  v_add_u32 v48, s63, v3
  v_max3_f32 v49, v16, v17, v18
  v_max3_f32 v50, v19, v20, v21
  v_max3_f32 v49, v49, v22, v23
  v_max3_f32 v50, v50, v24, v25
  v_max3_f32 v49, v49, v26, v27
  v_max3_f32 v50, v50, v28, v29
  v_max3_f32 v49, v49, v30, v31
  v_max_f32 v49, v49, v50
  s_mov_b64 exec, s[68:69]
  ds_write_b128 v48, v[40:43] offset:12288
  ds_write_b128 v48, v[44:47] offset:12544
  ds_max_f32 v4, v49 offset:2064
  ds_add_u32 v6, v7 offset:2060
  s_mov_b64 exec, 1
  ds_add_rtn_u32 v16, v6, v7 offset:2056
  ds_read_b32 v17, v6 offset:2128
  s_mov_b64 exec, -1
  s_waitcnt lgkmcnt(0)
  v_readfirstlane_b32 s35, v16
  v_readfirstlane_b32 s54, v17
  s_cmp_ge_u32 s35, 32
  s_cselect_b32 s35, s30, s35
  s_cselect_b32 s64, 4, 0
  s_add_u32 s30, s30, s64
  s_bfe_u32 s64, s35, 0x10000
  s_lshl_b32 s64, s64, 12
  s_or_b32 s60, s39, s64
  s_bfe_u32 s64, s35, 0x10001
  s_lshl_b32 s64, s64, 14
  s_or_b32 s60, s60, s64
  s_bfe_u32 s64, s35, 0x30002
  s_lshl_b32 s64, s64, 17
  s_or_b32 s60, s60, s64
  s_cmp_ge_u32 s35, 32
  s_cbranch_scc1 L_kv2
  s_cmp_ge_u32 s35, s54
  s_cbranch_scc1 L_kb2
  buffer_load_dwordx2 v[192:193], v1, s[8:11], s60 offen offset:0 nt
  buffer_load_dwordx2 v[194:195], v1, s[8:11], s60 offen offset:8 nt
  buffer_load_dwordx2 v[196:197], v1, s[8:11], s60 offen offset:128 nt
  buffer_load_dwordx2 v[198:199], v1, s[8:11], s60 offen offset:136 nt
  buffer_load_dwordx4 v[200:203], v1, s[8:11], s60 offen offset:2048 nt
  buffer_load_dwordx4 v[204:207], v1, s[8:11], s60 offen offset:2176 nt
  s_add_u32 s60, s60, 0x2000
  buffer_load_dwordx2 v[208:209], v1, s[8:11], s60 offen offset:0 nt
  buffer_load_dwordx2 v[210:211], v1, s[8:11], s60 offen offset:8 nt
  buffer_load_dwordx4 v[212:215], v1, s[8:11], s60 offen offset:128 nt
  buffer_load_dwordx4 v[216:219], v1, s[8:11], s60 offen offset:2048 nt
  buffer_load_dwordx4 v[220:223], v1, s[8:11], s60 offen offset:2176 nt
  s_add_u32 s60, s60, 0x6000
  buffer_load_dwordx2 v[224:225], v1, s[8:11], s60 offen offset:0 nt
  buffer_load_dwordx2 v[226:227], v1, s[8:11], s60 offen offset:8 nt
  buffer_load_dwordx2 v[228:229], v1, s[8:11], s60 offen offset:128 nt
  buffer_load_dwordx2 v[230:231], v1, s[8:11], s60 offen offset:136 nt
  buffer_load_dwordx4 v[232:235], v1, s[8:11], s60 offen offset:2048 nt
  buffer_load_dwordx4 v[236:239], v1, s[8:11], s60 offen offset:2176 nt
  s_add_u32 s60, s60, 0x2000
  buffer_load_dwordx2 v[240:241], v1, s[8:11], s60 offen offset:0 nt
  buffer_load_dwordx2 v[242:243], v1, s[8:11], s60 offen offset:8 nt
  buffer_load_dwordx4 v[244:247], v1, s[8:11], s60 offen offset:128 nt
  buffer_load_dwordx4 v[248:251], v1, s[8:11], s60 offen offset:2048 nt
  buffer_load_dwordx4 v[252:255], v1, s[8:11], s60 offen offset:2176 nt
  s_branch L_k0
L_kb0:
  buffer_load_dwordx4 v[64:67], v1, s[8:11], s60 offen offset:0 nt
  buffer_load_dwordx4 v[68:71], v1, s[8:11], s60 offen offset:128 nt
  buffer_load_dwordx4 v[72:75], v1, s[8:11], s60 offen offset:2048 nt
  buffer_load_dwordx4 v[76:79], v1, s[8:11], s60 offen offset:2176 nt
  s_add_u32 s60, s60, 0x2000
  buffer_load_dwordx4 v[80:83], v1, s[8:11], s60 offen offset:0 nt
  buffer_load_dwordx4 v[84:87], v1, s[8:11], s60 offen offset:128 nt
  buffer_load_dwordx4 v[88:91], v1, s[8:11], s60 offen offset:2048 nt
  buffer_load_dwordx4 v[92:95], v1, s[8:11], s60 offen offset:2176 nt
  s_add_u32 s60, s60, 0x6000
  buffer_load_dwordx4 v[96:99], v1, s[8:11], s60 offen offset:0 nt
  buffer_load_dwordx4 v[100:103], v1, s[8:11], s60 offen offset:128 nt
  buffer_load_dwordx4 v[104:107], v1, s[8:11], s60 offen offset:2048 nt
  buffer_load_dwordx4 v[108:111], v1, s[8:11], s60 offen offset:2176 nt
  s_add_u32 s60, s60, 0x2000
  buffer_load_dwordx4 v[112:115], v1, s[8:11], s60 offen offset:0 nt
  buffer_load_dwordx4 v[116:119], v1, s[8:11], s60 offen offset:128 nt
  buffer_load_dwordx4 v[120:123], v1, s[8:11], s60 offen offset:2048 nt
  buffer_load_dwordx4 v[124:127], v1, s[8:11], s60 offen offset:2176 nt
  s_branch L_k1
L_kv0:
  s_cmp_ge_u32 s33, s54
  s_cbranch_scc1 L_kvb0
  buffer_load_dwordx2 v[64:65], v2, s[12:15], s60 offen offset:0 nt
  buffer_load_dwordx2 v[66:67], v2, s[12:15], s60 offen offset:8 nt
  buffer_load_dwordx2 v[68:69], v2, s[12:15], s60 offen offset:1024 nt
  buffer_load_dwordx2 v[70:71], v2, s[12:15], s60 offen offset:1032 nt
  buffer_load_dwordx4 v[72:75], v2, s[12:15], s60 offen offset:2048 nt
  buffer_load_dwordx4 v[76:79], v2, s[12:15], s60 offen offset:3072 nt
  s_add_u32 s60, s60, 0x2000
  buffer_load_dwordx2 v[80:81], v2, s[12:15], s60 offen offset:0 nt
  buffer_load_dwordx2 v[82:83], v2, s[12:15], s60 offen offset:8 nt
  buffer_load_dwordx4 v[84:87], v2, s[12:15], s60 offen offset:1024 nt
  buffer_load_dwordx4 v[88:91], v2, s[12:15], s60 offen offset:2048 nt
  buffer_load_dwordx4 v[92:95], v2, s[12:15], s60 offen offset:3072 nt
  s_add_u32 s60, s60, 0x6000
  buffer_load_dwordx2 v[96:97], v2, s[12:15], s60 offen offset:0 nt
  buffer_load_dwordx2 v[98:99], v2, s[12:15], s60 offen offset:8 nt
  buffer_load_dwordx2 v[100:101], v2, s[12:15], s60 offen offset:1024 nt
  buffer_load_dwordx2 v[102:103], v2, s[12:15], s60 offen offset:1032 nt
  buffer_load_dwordx4 v[104:107], v2, s[12:15], s60 offen offset:2048 nt
  buffer_load_dwordx4 v[108:111], v2, s[12:15], s60 offen offset:3072 nt
  s_add_u32 s60, s60, 0x2000
  buffer_load_dwordx2 v[112:113], v2, s[12:15], s60 offen offset:0 nt
  buffer_load_dwordx2 v[114:115], v2, s[12:15], s60 offen offset:8 nt
  buffer_load_dwordx4 v[116:119], v2, s[12:15], s60 offen offset:1024 nt
  buffer_load_dwordx4 v[120:123], v2, s[12:15], s60 offen offset:2048 nt
  buffer_load_dwordx4 v[124:127], v2, s[12:15], s60 offen offset:3072 nt
  s_branch L_k1
L_kvb0:
  buffer_load_dwordx4 v[64:67], v2, s[12:15], s60 offen offset:0 nt
  buffer_load_dwordx4 v[68:71], v2, s[12:15], s60 offen offset:1024 nt
  buffer_load_dwordx4 v[72:75], v2, s[12:15], s60 offen offset:2048 nt
  buffer_load_dwordx4 v[76:79], v2, s[12:15], s60 offen offset:3072 nt
  s_add_u32 s60, s60, 0x2000
  buffer_load_dwordx4 v[80:83], v2, s[12:15], s60 offen offset:0 nt
  buffer_load_dwordx4 v[84:87], v2, s[12:15], s60 offen offset:1024 nt
  buffer_load_dwordx4 v[88:91], v2, s[12:15], s60 offen offset:2048 nt
  buffer_load_dwordx4 v[92:95], v2, s[12:15], s60 offen offset:3072 nt
  s_add_u32 s60, s60, 0x6000
  buffer_load_dwordx4 v[96:99], v2, s[12:15], s60 offen offset:0 nt
  buffer_load_dwordx4 v[100:103], v2, s[12:15], s60 offen offset:1024 nt
  buffer_load_dwordx4 v[104:107], v2, s[12:15], s60 offen offset:2048 nt
  buffer_load_dwordx4 v[108:111], v2, s[12:15], s60 offen offset:3072 nt
  s_add_u32 s60, s60, 0x2000
  buffer_load_dwordx4 v[112:115], v2, s[12:15], s60 offen offset:0 nt
  buffer_load_dwordx4 v[116:119], v2, s[12:15], s60 offen offset:1024 nt
  buffer_load_dwordx4 v[120:123], v2, s[12:15], s60 offen offset:2048 nt
  buffer_load_dwordx4 v[124:127], v2, s[12:15], s60 offen offset:3072 nt
  s_branch L_k1
L_kb1:
  buffer_load_dwordx4 v[128:131], v1, s[8:11], s60 offen offset:0 nt
  buffer_load_dwordx4 v[132:135], v1, s[8:11], s60 offen offset:128 nt
  buffer_load_dwordx4 v[136:139], v1, s[8:11], s60 offen offset:2048 nt
  buffer_load_dwordx4 v[140:143], v1, s[8:11], s60 offen offset:2176 nt
  s_add_u32 s60, s60, 0x2000
  buffer_load_dwordx4 v[144:147], v1, s[8:11], s60 offen offset:0 nt
  buffer_load_dwordx4 v[148:151], v1, s[8:11], s60 offen offset:128 nt
  buffer_load_dwordx4 v[152:155], v1, s[8:11], s60 offen offset:2048 nt
  buffer_load_dwordx4 v[156:159], v1, s[8:11], s60 offen offset:2176 nt
  s_add_u32 s60, s60, 0x6000
  buffer_load_dwordx4 v[160:163], v1, s[8:11], s60 offen offset:0 nt
  buffer_load_dwordx4 v[164:167], v1, s[8:11], s60 offen offset:128 nt
  buffer_load_dwordx4 v[168:171], v1, s[8:11], s60 offen offset:2048 nt
  buffer_load_dwordx4 v[172:175], v1, s[8:11], s60 offen offset:2176 nt
  s_add_u32 s60, s60, 0x2000
  buffer_load_dwordx4 v[176:179], v1, s[8:11], s60 offen offset:0 nt
  buffer_load_dwordx4 v[180:183], v1, s[8:11], s60 offen offset:128 nt
  buffer_load_dwordx4 v[184:187], v1, s[8:11], s60 offen offset:2048 nt
  buffer_load_dwordx4 v[188:191], v1, s[8:11], s60 offen offset:2176 nt
  s_branch L_k2
L_kv1:
  s_cmp_ge_u32 s34, s54
  s_cbranch_scc1 L_kvb1
  buffer_load_dwordx2 v[128:129], v2, s[12:15], s60 offen offset:0 nt
  buffer_load_dwordx2 v[130:131], v2, s[12:15], s60 offen offset:8 nt
  buffer_load_dwordx2 v[132:133], v2, s[12:15], s60 offen offset:1024 nt
  buffer_load_dwordx2 v[134:135], v2, s[12:15], s60 offen offset:1032 nt
  buffer_load_dwordx4 v[136:139], v2, s[12:15], s60 offen offset:2048 nt
  buffer_load_dwordx4 v[140:143], v2, s[12:15], s60 offen offset:3072 nt
  s_add_u32 s60, s60, 0x2000
  buffer_load_dwordx2 v[144:145], v2, s[12:15], s60 offen offset:0 nt
  buffer_load_dwordx2 v[146:147], v2, s[12:15], s60 offen offset:8 nt
  buffer_load_dwordx4 v[148:151], v2, s[12:15], s60 offen offset:1024 nt
  buffer_load_dwordx4 v[152:155], v2, s[12:15], s60 offen offset:2048 nt
  buffer_load_dwordx4 v[156:159], v2, s[12:15], s60 offen offset:3072 nt
  s_add_u32 s60, s60, 0x6000
  buffer_load_dwordx2 v[160:161], v2, s[12:15], s60 offen offset:0 nt
  buffer_load_dwordx2 v[162:163], v2, s[12:15], s60 offen offset:8 nt
  buffer_load_dwordx2 v[164:165], v2, s[12:15], s60 offen offset:1024 nt
  buffer_load_dwordx2 v[166:167], v2, s[12:15], s60 offen offset:1032 nt
  buffer_load_dwordx4 v[168:171], v2, s[12:15], s60 offen offset:2048 nt
  buffer_load_dwordx4 v[172:175], v2, s[12:15], s60 offen offset:3072 nt
  s_add_u32 s60, s60, 0x2000
  buffer_load_dwordx2 v[176:177], v2, s[12:15], s60 offen offset:0 nt
  buffer_load_dwordx2 v[178:179], v2, s[12:15], s60 offen offset:8 nt
  buffer_load_dwordx4 v[180:183], v2, s[12:15], s60 offen offset:1024 nt
  buffer_load_dwordx4 v[184:187], v2, s[12:15], s60 offen offset:2048 nt
  buffer_load_dwordx4 v[188:191], v2, s[12:15], s60 offen offset:3072 nt
  s_branch L_k2
L_kvb1:
  buffer_load_dwordx4 v[128:131], v2, s[12:15], s60 offen offset:0 nt
  buffer_load_dwordx4 v[132:135], v2, s[12:15], s60 offen offset:1024 nt
  buffer_load_dwordx4 v[136:139], v2, s[12:15], s60 offen offset:2048 nt
  buffer_load_dwordx4 v[140:143], v2, s[12:15], s60 offen offset:3072 nt
  s_add_u32 s60, s60, 0x2000
  buffer_load_dwordx4 v[144:147], v2, s[12:15], s60 offen offset:0 nt
  buffer_load_dwordx4 v[148:151], v2, s[12:15], s60 offen offset:1024 nt
  buffer_load_dwordx4 v[152:155], v2, s[12:15], s60 offen offset:2048 nt
  buffer_load_dwordx4 v[156:159], v2, s[12:15], s60 offen offset:3072 nt
  s_add_u32 s60, s60, 0x6000
  buffer_load_dwordx4 v[160:163], v2, s[12:15], s60 offen offset:0 nt
  buffer_load_dwordx4 v[164:167], v2, s[12:15], s60 offen offset:1024 nt
  buffer_load_dwordx4 v[168:171], v2, s[12:15], s60 offen offset:2048 nt
  buffer_load_dwordx4 v[172:175], v2, s[12:15], s60 offen offset:3072 nt
  s_add_u32 s60, s60, 0x2000
  buffer_load_dwordx4 v[176:179], v2, s[12:15], s60 offen offset:0 nt
  buffer_load_dwordx4 v[180:183], v2, s[12:15], s60 offen offset:1024 nt
  buffer_load_dwordx4 v[184:187], v2, s[12:15], s60 offen offset:2048 nt
  buffer_load_dwordx4 v[188:191], v2, s[12:15], s60 offen offset:3072 nt
  s_branch L_k2
L_kb2:
  buffer_load_dwordx4 v[192:195], v1, s[8:11], s60 offen offset:0 nt
  buffer_load_dwordx4 v[196:199], v1, s[8:11], s60 offen offset:128 nt
  buffer_load_dwordx4 v[200:203], v1, s[8:11], s60 offen offset:2048 nt
  buffer_load_dwordx4 v[204:207], v1, s[8:11], s60 offen offset:2176 nt
  s_add_u32 s60, s60, 0x2000
  buffer_load_dwordx4 v[208:211], v1, s[8:11], s60 offen offset:0 nt
  buffer_load_dwordx4 v[212:215], v1, s[8:11], s60 offen offset:128 nt
  buffer_load_dwordx4 v[216:219], v1, s[8:11], s60 offen offset:2048 nt
  buffer_load_dwordx4 v[220:223], v1, s[8:11], s60 offen offset:2176 nt
  s_add_u32 s60, s60, 0x6000
  buffer_load_dwordx4 v[224:227], v1, s[8:11], s60 offen offset:0 nt
  buffer_load_dwordx4 v[228:231], v1, s[8:11], s60 offen offset:128 nt
  buffer_load_dwordx4 v[232:235], v1, s[8:11], s60 offen offset:2048 nt
  buffer_load_dwordx4 v[236:239], v1, s[8:11], s60 offen offset:2176 nt
  s_add_u32 s60, s60, 0x2000
  buffer_load_dwordx4 v[240:243], v1, s[8:11], s60 offen offset:0 nt
  buffer_load_dwordx4 v[244:247], v1, s[8:11], s60 offen offset:128 nt
  buffer_load_dwordx4 v[248:251], v1, s[8:11], s60 offen offset:2048 nt
  buffer_load_dwordx4 v[252:255], v1, s[8:11], s60 offen offset:2176 nt
  s_branch L_k0
L_kv2:
  s_cmp_ge_u32 s35, s54
  s_cbranch_scc1 L_kvb2
  buffer_load_dwordx2 v[192:193], v2, s[12:15], s60 offen offset:0 nt
  buffer_load_dwordx2 v[194:195], v2, s[12:15], s60 offen offset:8 nt
  buffer_load_dwordx2 v[196:197], v2, s[12:15], s60 offen offset:1024 nt
  buffer_load_dwordx2 v[198:199], v2, s[12:15], s60 offen offset:1032 nt
  buffer_load_dwordx4 v[200:203], v2, s[12:15], s60 offen offset:2048 nt
  buffer_load_dwordx4 v[204:207], v2, s[12:15], s60 offen offset:3072 nt
  s_add_u32 s60, s60, 0x2000
  buffer_load_dwordx2 v[208:209], v2, s[12:15], s60 offen offset:0 nt
  buffer_load_dwordx2 v[210:211], v2, s[12:15], s60 offen offset:8 nt
  buffer_load_dwordx4 v[212:215], v2, s[12:15], s60 offen offset:1024 nt
  buffer_load_dwordx4 v[216:219], v2, s[12:15], s60 offen offset:2048 nt
  buffer_load_dwordx4 v[220:223], v2, s[12:15], s60 offen offset:3072 nt
  s_add_u32 s60, s60, 0x6000
  buffer_load_dwordx2 v[224:225], v2, s[12:15], s60 offen offset:0 nt
  buffer_load_dwordx2 v[226:227], v2, s[12:15], s60 offen offset:8 nt
  buffer_load_dwordx2 v[228:229], v2, s[12:15], s60 offen offset:1024 nt
  buffer_load_dwordx2 v[230:231], v2, s[12:15], s60 offen offset:1032 nt
  buffer_load_dwordx4 v[232:235], v2, s[12:15], s60 offen offset:2048 nt
  buffer_load_dwordx4 v[236:239], v2, s[12:15], s60 offen offset:3072 nt
  s_add_u32 s60, s60, 0x2000
  buffer_load_dwordx2 v[240:241], v2, s[12:15], s60 offen offset:0 nt
  buffer_load_dwordx2 v[242:243], v2, s[12:15], s60 offen offset:8 nt
  buffer_load_dwordx4 v[244:247], v2, s[12:15], s60 offen offset:1024 nt
  buffer_load_dwordx4 v[248:251], v2, s[12:15], s60 offen offset:2048 nt
  buffer_load_dwordx4 v[252:255], v2, s[12:15], s60 offen offset:3072 nt
  s_branch L_k0
L_kvb2:
  buffer_load_dwordx4 v[192:195], v2, s[12:15], s60 offen offset:0 nt
  buffer_load_dwordx4 v[196:199], v2, s[12:15], s60 offen offset:1024 nt
  buffer_load_dwordx4 v[200:203], v2, s[12:15], s60 offen offset:2048 nt
  buffer_load_dwordx4 v[204:207], v2, s[12:15], s60 offen offset:3072 nt
  s_add_u32 s60, s60, 0x2000
  buffer_load_dwordx4 v[208:211], v2, s[12:15], s60 offen offset:0 nt
  buffer_load_dwordx4 v[212:215], v2, s[12:15], s60 offen offset:1024 nt
  buffer_load_dwordx4 v[216:219], v2, s[12:15], s60 offen offset:2048 nt
  buffer_load_dwordx4 v[220:223], v2, s[12:15], s60 offen offset:3072 nt
  s_add_u32 s60, s60, 0x6000
  buffer_load_dwordx4 v[224:227], v2, s[12:15], s60 offen offset:0 nt
  buffer_load_dwordx4 v[228:231], v2, s[12:15], s60 offen offset:1024 nt
  buffer_load_dwordx4 v[232:235], v2, s[12:15], s60 offen offset:2048 nt
  buffer_load_dwordx4 v[236:239], v2, s[12:15], s60 offen offset:3072 nt
  s_add_u32 s60, s60, 0x2000
  buffer_load_dwordx4 v[240:243], v2, s[12:15], s60 offen offset:0 nt
  buffer_load_dwordx4 v[244:247], v2, s[12:15], s60 offen offset:1024 nt
  buffer_load_dwordx4 v[248:251], v2, s[12:15], s60 offen offset:2048 nt
  buffer_load_dwordx4 v[252:255], v2, s[12:15], s60 offen offset:3072 nt
  s_branch L_k0
L_tr0:
  s_mov_b32 s67, 0
  s_branch L_trans
L_tr1:
  s_mov_b32 s67, 1
  s_branch L_trans
L_tr2:
  s_mov_b32 s67, 2
L_trans:
  v_mov_b32 v32, 0
  v_mov_b32 v33, 0
  v_mov_b32 v34, 0
  v_mov_b32 v35, 0
  v_mov_b32 v36, 0
  v_mov_b32 v37, 0
  v_mov_b32 v38, 0
  v_mov_b32 v39, 0
  v_mov_b32 v40, 0
  v_mov_b32 v41, 0
  v_mov_b32 v42, 0
  v_mov_b32 v43, 0
  v_mov_b32 v44, 0
  v_mov_b32 v45, 0
  v_mov_b32 v46, 0
  v_mov_b32 v47, 0
  v_mov_b32 v48, 0
  v_mov_b32 v49, 0
  v_mov_b32 v50, 0
  v_mov_b32 v51, 0
  v_mov_b32 v52, 0
  v_mov_b32 v53, 0
  v_mov_b32 v54, 0
  v_mov_b32 v55, 0
  v_mov_b32 v56, 0
  v_mov_b32 v57, 0
  v_mov_b32 v58, 0
  v_mov_b32 v59, 0
  v_mov_b32 v60, 0
  v_mov_b32 v61, 0
  v_mov_b32 v62, 0
  v_mov_b32 v63, 0
  s_mov_b32 s72, 0
L_wkd:
  ds_read_b32 v16, v6 offset:2060
  s_add_u32 s72, s72, 1
  s_waitcnt lgkmcnt(0)
  v_cmp_le_u32 vcc, 512, v16
  s_cbranch_vccnz L_gkd
  s_sleep 1
  s_cmp_lt_u32 s72, 0x400000
  s_cbranch_scc1 L_wkd
L_gkd:
  ds_read_b32 v5, v4 offset:2064
  s_waitcnt lgkmcnt(0)
  v_cvt_pk_bf16_f32 v5, v5, v5
  v_lshlrev_b32 v5, 16, v5
  v_mul_f32 v5, s59, v5
  s_cmp_eq_u32 s67, 1
  s_cbranch_scc1 L_v1
  s_cmp_eq_u32 s67, 2
  s_cbranch_scc1 L_v2
.p2align 3
L_v0:
  s_lshl_b32 s63, s33, 9
  s_sub_u32 s63, s63, 4096
  v_add_u32 v16, s63, v3
  ds_read_b128 v[8:11], v16
  ds_read_b128 v[12:15], v16 offset:256
  s_cmp_eq_u32 s55, 2
  s_waitcnt lgkmcnt(0)
  v_lshlrev_b32 v16, 16, v8
  v_and_b32 v17, s73, v8
  v_lshlrev_b32 v18, 16, v9
  v_and_b32 v19, s73, v9
  v_lshlrev_b32 v20, 16, v10
  v_and_b32 v21, s73, v10
  v_lshlrev_b32 v22, 16, v11
  v_and_b32 v23, s73, v11
  v_lshlrev_b32 v24, 16, v12
  v_and_b32 v25, s73, v12
  v_lshlrev_b32 v26, 16, v13
  v_and_b32 v27, s73, v13
  v_lshlrev_b32 v28, 16, v14
  v_and_b32 v29, s73, v14
  v_lshlrev_b32 v30, 16, v15
  v_and_b32 v31, s73, v15
  v_fma_f32 v16, v16, s59, -v5
  v_fma_f32 v17, v17, s59, -v5
  v_fma_f32 v18, v18, s59, -v5
  v_fma_f32 v19, v19, s59, -v5
  v_fma_f32 v20, v20, s59, -v5
  v_fma_f32 v21, v21, s59, -v5
  v_fma_f32 v22, v22, s59, -v5
  v_fma_f32 v23, v23, s59, -v5
  v_fma_f32 v24, v24, s59, -v5
  v_fma_f32 v25, v25, s59, -v5
  v_fma_f32 v26, v26, s59, -v5
  v_fma_f32 v27, v27, s59, -v5
  v_fma_f32 v28, v28, s59, -v5
  v_fma_f32 v29, v29, s59, -v5
  v_fma_f32 v30, v30, s59, -v5
  v_fma_f32 v31, v31, s59, -v5
  v_exp_f32 v16, v16
  v_exp_f32 v17, v17
  v_exp_f32 v18, v18
  v_exp_f32 v19, v19
  v_exp_f32 v20, v20
  v_exp_f32 v21, v21
  v_exp_f32 v22, v22
  v_exp_f32 v23, v23
  v_exp_f32 v24, v24
  v_exp_f32 v25, v25
  v_exp_f32 v26, v26
  v_exp_f32 v27, v27
  v_exp_f32 v28, v28
  v_exp_f32 v29, v29
  v_exp_f32 v30, v30
  v_exp_f32 v31, v31
  v_cvt_pk_bf16_f32 v8, v16, v17
  v_cvt_pk_bf16_f32 v9, v18, v19
  v_cvt_pk_bf16_f32 v10, v20, v21
  v_cvt_pk_bf16_f32 v11, v22, v23
  v_cvt_pk_bf16_f32 v12, v24, v25
  v_cvt_pk_bf16_f32 v13, v26, v27
  v_cvt_pk_bf16_f32 v14, v28, v29
  v_cvt_pk_bf16_f32 v15, v30, v31
  s_waitcnt vmcnt(40)
  s_cbranch_scc0 L_w00
  s_waitcnt vmcnt(12)
L_w00:
  v_perm_b32 v16, v68, v64, s56
  v_perm_b32 v17, v76, v72, s56
  v_perm_b32 v18, v84, v80, s56
  v_perm_b32 v19, v92, v88, s56
  v_perm_b32 v20, v68, v64, s57
  v_perm_b32 v21, v76, v72, s57
  v_perm_b32 v22, v84, v80, s57
  v_perm_b32 v23, v92, v88, s57
  v_mfma_f32_16x16x32_bf16 v[32:35], v[16:19], v[8:11], v[32:35]
  v_perm_b32 v24, v69, v65, s56
  v_perm_b32 v25, v77, v73, s56
  v_perm_b32 v26, v85, v81, s56
  v_perm_b32 v27, v93, v89, s56
  v_mfma_f32_16x16x32_bf16 v[36:39], v[20:23], v[8:11], v[36:39]
  v_perm_b32 v28, v69, v65, s57
  v_perm_b32 v29, v77, v73, s57
  v_perm_b32 v30, v85, v81, s57
  v_perm_b32 v31, v93, v89, s57
  v_mfma_f32_16x16x32_bf16 v[40:43], v[24:27], v[8:11], v[40:43]
  v_perm_b32 v16, v70, v66, s56
  v_perm_b32 v17, v78, v74, s56
  v_perm_b32 v18, v86, v82, s56
  v_perm_b32 v19, v94, v90, s56
  v_mfma_f32_16x16x32_bf16 v[44:47], v[28:31], v[8:11], v[44:47]
  v_perm_b32 v20, v70, v66, s57
  v_perm_b32 v21, v78, v74, s57
  v_perm_b32 v22, v86, v82, s57
  v_perm_b32 v23, v94, v90, s57
  v_mfma_f32_16x16x32_bf16 v[48:51], v[16:19], v[8:11], v[48:51]
  v_perm_b32 v24, v71, v67, s56
  v_perm_b32 v25, v79, v75, s56
  v_perm_b32 v26, v87, v83, s56
  v_perm_b32 v27, v95, v91, s56
  v_mfma_f32_16x16x32_bf16 v[52:55], v[20:23], v[8:11], v[52:55]
  v_perm_b32 v28, v71, v67, s57
  v_perm_b32 v29, v79, v75, s57
  v_perm_b32 v30, v87, v83, s57
  v_perm_b32 v31, v95, v91, s57
  v_mfma_f32_16x16x32_bf16 v[56:59], v[24:27], v[8:11], v[56:59]
  s_nop 0
  v_mfma_f32_16x16x32_bf16 v[60:63], v[28:31], v[8:11], v[60:63]
  s_waitcnt vmcnt(32)
  s_cbranch_scc0 L_w01
  s_waitcnt vmcnt(4)
L_w01:
  v_perm_b32 v16, v100, v96, s56
  v_perm_b32 v17, v108, v104, s56
  v_perm_b32 v18, v116, v112, s56
  v_perm_b32 v19, v124, v120, s56
  v_perm_b32 v20, v100, v96, s57
  v_perm_b32 v21, v108, v104, s57
  v_perm_b32 v22, v116, v112, s57
  v_perm_b32 v23, v124, v120, s57
  v_mfma_f32_16x16x32_bf16 v[32:35], v[16:19], v[12:15], v[32:35]
  v_perm_b32 v24, v101, v97, s56
  v_perm_b32 v25, v109, v105, s56
  v_perm_b32 v26, v117, v113, s56
  v_perm_b32 v27, v125, v121, s56
  v_mfma_f32_16x16x32_bf16 v[36:39], v[20:23], v[12:15], v[36:39]
  v_perm_b32 v28, v101, v97, s57
  v_perm_b32 v29, v109, v105, s57
  v_perm_b32 v30, v117, v113, s57
  v_perm_b32 v31, v125, v121, s57
  v_mfma_f32_16x16x32_bf16 v[40:43], v[24:27], v[12:15], v[40:43]
  v_perm_b32 v16, v102, v98, s56
  v_perm_b32 v17, v110, v106, s56
  v_perm_b32 v18, v118, v114, s56
  v_perm_b32 v19, v126, v122, s56
  v_mfma_f32_16x16x32_bf16 v[44:47], v[28:31], v[12:15], v[44:47]
  v_perm_b32 v20, v102, v98, s57
  v_perm_b32 v21, v110, v106, s57
  v_perm_b32 v22, v118, v114, s57
  v_perm_b32 v23, v126, v122, s57
  v_mfma_f32_16x16x32_bf16 v[48:51], v[16:19], v[12:15], v[48:51]
  v_perm_b32 v24, v103, v99, s56
  v_perm_b32 v25, v111, v107, s56
  v_perm_b32 v26, v119, v115, s56
  v_perm_b32 v27, v127, v123, s56
  v_mfma_f32_16x16x32_bf16 v[52:55], v[20:23], v[12:15], v[52:55]
  v_perm_b32 v28, v103, v99, s57
  v_perm_b32 v29, v111, v107, s57
  v_perm_b32 v30, v119, v115, s57
  v_perm_b32 v31, v127, v123, s57
  v_mfma_f32_16x16x32_bf16 v[56:59], v[24:27], v[12:15], v[56:59]
  s_nop 0
  v_mfma_f32_16x16x32_bf16 v[60:63], v[28:31], v[12:15], v[60:63]
  s_cmp_lg_u32 s55, 0
  s_cbranch_scc1 L_dr0
  s_mov_b64 exec, 1
  ds_add_rtn_u32 v16, v6, v7 offset:2056
  ds_read_b32 v17, v6 offset:2128
  s_mov_b64 exec, -1
  s_waitcnt lgkmcnt(0)
  v_readfirstlane_b32 s33, v16
  v_readfirstlane_b32 s54, v17
  s_cmp_ge_u32 s33, 32
  s_cselect_b32 s33, s30, s33
  s_cselect_b32 s64, 4, 0
  s_add_u32 s30, s30, s64
  s_bfe_u32 s64, s33, 0x10000
  s_lshl_b32 s64, s64, 12
  s_or_b32 s60, s39, s64
  s_bfe_u32 s64, s33, 0x10001
  s_lshl_b32 s64, s64, 14
  s_or_b32 s60, s60, s64
  s_bfe_u32 s64, s33, 0x30002
  s_lshl_b32 s64, s64, 17
  s_or_b32 s60, s60, s64
  s_cmp_ge_u32 s33, s54
  s_cbranch_scc1 L_ve0
  buffer_load_dwordx2 v[64:65], v2, s[12:15], s60 offen offset:0 nt
  buffer_load_dwordx2 v[66:67], v2, s[12:15], s60 offen offset:8 nt
  buffer_load_dwordx2 v[68:69], v2, s[12:15], s60 offen offset:1024 nt
  buffer_load_dwordx2 v[70:71], v2, s[12:15], s60 offen offset:1032 nt
  buffer_load_dwordx4 v[72:75], v2, s[12:15], s60 offen offset:2048 nt
  buffer_load_dwordx4 v[76:79], v2, s[12:15], s60 offen offset:3072 nt
  s_add_u32 s60, s60, 0x2000
  buffer_load_dwordx2 v[80:81], v2, s[12:15], s60 offen offset:0 nt
  buffer_load_dwordx2 v[82:83], v2, s[12:15], s60 offen offset:8 nt
  buffer_load_dwordx4 v[84:87], v2, s[12:15], s60 offen offset:1024 nt
  buffer_load_dwordx4 v[88:91], v2, s[12:15], s60 offen offset:2048 nt
  buffer_load_dwordx4 v[92:95], v2, s[12:15], s60 offen offset:3072 nt
  s_add_u32 s60, s60, 0x6000
  buffer_load_dwordx2 v[96:97], v2, s[12:15], s60 offen offset:0 nt
  buffer_load_dwordx2 v[98:99], v2, s[12:15], s60 offen offset:8 nt
  buffer_load_dwordx2 v[100:101], v2, s[12:15], s60 offen offset:1024 nt
  buffer_load_dwordx2 v[102:103], v2, s[12:15], s60 offen offset:1032 nt
  buffer_load_dwordx4 v[104:107], v2, s[12:15], s60 offen offset:2048 nt
  buffer_load_dwordx4 v[108:111], v2, s[12:15], s60 offen offset:3072 nt
  s_add_u32 s60, s60, 0x2000
  buffer_load_dwordx2 v[112:113], v2, s[12:15], s60 offen offset:0 nt
  buffer_load_dwordx2 v[114:115], v2, s[12:15], s60 offen offset:8 nt
  buffer_load_dwordx4 v[116:119], v2, s[12:15], s60 offen offset:1024 nt
  buffer_load_dwordx4 v[120:123], v2, s[12:15], s60 offen offset:2048 nt
  buffer_load_dwordx4 v[124:127], v2, s[12:15], s60 offen offset:3072 nt
L_v1:
  s_lshl_b32 s63, s34, 9
  s_sub_u32 s63, s63, 4096
  v_add_u32 v16, s63, v3
  ds_read_b128 v[8:11], v16
  ds_read_b128 v[12:15], v16 offset:256
  s_cmp_eq_u32 s55, 2
  s_waitcnt lgkmcnt(0)
  v_lshlrev_b32 v16, 16, v8
  v_and_b32 v17, s73, v8
  v_lshlrev_b32 v18, 16, v9
  v_and_b32 v19, s73, v9
  v_lshlrev_b32 v20, 16, v10
  v_and_b32 v21, s73, v10
  v_lshlrev_b32 v22, 16, v11
  v_and_b32 v23, s73, v11
  v_lshlrev_b32 v24, 16, v12
  v_and_b32 v25, s73, v12
  v_lshlrev_b32 v26, 16, v13
  v_and_b32 v27, s73, v13
  v_lshlrev_b32 v28, 16, v14
  v_and_b32 v29, s73, v14
  v_lshlrev_b32 v30, 16, v15
  v_and_b32 v31, s73, v15
  v_fma_f32 v16, v16, s59, -v5
  v_fma_f32 v17, v17, s59, -v5
  v_fma_f32 v18, v18, s59, -v5
  v_fma_f32 v19, v19, s59, -v5
  v_fma_f32 v20, v20, s59, -v5
  v_fma_f32 v21, v21, s59, -v5
  v_fma_f32 v22, v22, s59, -v5
  v_fma_f32 v23, v23, s59, -v5
  v_fma_f32 v24, v24, s59, -v5
  v_fma_f32 v25, v25, s59, -v5
  v_fma_f32 v26, v26, s59, -v5
  v_fma_f32 v27, v27, s59, -v5
  v_fma_f32 v28, v28, s59, -v5
  v_fma_f32 v29, v29, s59, -v5
  v_fma_f32 v30, v30, s59, -v5
  v_fma_f32 v31, v31, s59, -v5
  v_exp_f32 v16, v16
  v_exp_f32 v17, v17
  v_exp_f32 v18, v18
  v_exp_f32 v19, v19
  v_exp_f32 v20, v20
  v_exp_f32 v21, v21
  v_exp_f32 v22, v22
  v_exp_f32 v23, v23
  v_exp_f32 v24, v24
  v_exp_f32 v25, v25
  v_exp_f32 v26, v26
  v_exp_f32 v27, v27
  v_exp_f32 v28, v28
  v_exp_f32 v29, v29
  v_exp_f32 v30, v30
  v_exp_f32 v31, v31
  v_cvt_pk_bf16_f32 v8, v16, v17
  v_cvt_pk_bf16_f32 v9, v18, v19
  v_cvt_pk_bf16_f32 v10, v20, v21
  v_cvt_pk_bf16_f32 v11, v22, v23
  v_cvt_pk_bf16_f32 v12, v24, v25
  v_cvt_pk_bf16_f32 v13, v26, v27
  v_cvt_pk_bf16_f32 v14, v28, v29
  v_cvt_pk_bf16_f32 v15, v30, v31
  s_waitcnt vmcnt(40)
  s_cbranch_scc0 L_w10
  s_waitcnt vmcnt(12)
L_w10:
  v_perm_b32 v16, v132, v128, s56
  v_perm_b32 v17, v140, v136, s56
  v_perm_b32 v18, v148, v144, s56
  v_perm_b32 v19, v156, v152, s56
  v_perm_b32 v20, v132, v128, s57
  v_perm_b32 v21, v140, v136, s57
  v_perm_b32 v22, v148, v144, s57
  v_perm_b32 v23, v156, v152, s57
  v_mfma_f32_16x16x32_bf16 v[32:35], v[16:19], v[8:11], v[32:35]
  v_perm_b32 v24, v133, v129, s56
  v_perm_b32 v25, v141, v137, s56
  v_perm_b32 v26, v149, v145, s56
  v_perm_b32 v27, v157, v153, s56
  v_mfma_f32_16x16x32_bf16 v[36:39], v[20:23], v[8:11], v[36:39]
  v_perm_b32 v28, v133, v129, s57
  v_perm_b32 v29, v141, v137, s57
  v_perm_b32 v30, v149, v145, s57
  v_perm_b32 v31, v157, v153, s57
  v_mfma_f32_16x16x32_bf16 v[40:43], v[24:27], v[8:11], v[40:43]
  v_perm_b32 v16, v134, v130, s56
  v_perm_b32 v17, v142, v138, s56
  v_perm_b32 v18, v150, v146, s56
  v_perm_b32 v19, v158, v154, s56
  v_mfma_f32_16x16x32_bf16 v[44:47], v[28:31], v[8:11], v[44:47]
  v_perm_b32 v20, v134, v130, s57
  v_perm_b32 v21, v142, v138, s57
  v_perm_b32 v22, v150, v146, s57
  v_perm_b32 v23, v158, v154, s57
  v_mfma_f32_16x16x32_bf16 v[48:51], v[16:19], v[8:11], v[48:51]
  v_perm_b32 v24, v135, v131, s56
  v_perm_b32 v25, v143, v139, s56
  v_perm_b32 v26, v151, v147, s56
  v_perm_b32 v27, v159, v155, s56
  v_mfma_f32_16x16x32_bf16 v[52:55], v[20:23], v[8:11], v[52:55]
  v_perm_b32 v28, v135, v131, s57
  v_perm_b32 v29, v143, v139, s57
  v_perm_b32 v30, v151, v147, s57
  v_perm_b32 v31, v159, v155, s57
  v_mfma_f32_16x16x32_bf16 v[56:59], v[24:27], v[8:11], v[56:59]
  s_nop 0
  v_mfma_f32_16x16x32_bf16 v[60:63], v[28:31], v[8:11], v[60:63]
  s_waitcnt vmcnt(32)
  s_cbranch_scc0 L_w11
  s_waitcnt vmcnt(4)
L_w11:
  v_perm_b32 v16, v164, v160, s56
  v_perm_b32 v17, v172, v168, s56
  v_perm_b32 v18, v180, v176, s56
  v_perm_b32 v19, v188, v184, s56
  v_perm_b32 v20, v164, v160, s57
  v_perm_b32 v21, v172, v168, s57
  v_perm_b32 v22, v180, v176, s57
  v_perm_b32 v23, v188, v184, s57
  v_mfma_f32_16x16x32_bf16 v[32:35], v[16:19], v[12:15], v[32:35]
  v_perm_b32 v24, v165, v161, s56
  v_perm_b32 v25, v173, v169, s56
  v_perm_b32 v26, v181, v177, s56
  v_perm_b32 v27, v189, v185, s56
  v_mfma_f32_16x16x32_bf16 v[36:39], v[20:23], v[12:15], v[36:39]
  v_perm_b32 v28, v165, v161, s57
  v_perm_b32 v29, v173, v169, s57
  v_perm_b32 v30, v181, v177, s57
  v_perm_b32 v31, v189, v185, s57
  v_mfma_f32_16x16x32_bf16 v[40:43], v[24:27], v[12:15], v[40:43]
  v_perm_b32 v16, v166, v162, s56
  v_perm_b32 v17, v174, v170, s56
  v_perm_b32 v18, v182, v178, s56
  v_perm_b32 v19, v190, v186, s56
  v_mfma_f32_16x16x32_bf16 v[44:47], v[28:31], v[12:15], v[44:47]
  v_perm_b32 v20, v166, v162, s57
  v_perm_b32 v21, v174, v170, s57
  v_perm_b32 v22, v182, v178, s57
  v_perm_b32 v23, v190, v186, s57
  v_mfma_f32_16x16x32_bf16 v[48:51], v[16:19], v[12:15], v[48:51]
  v_perm_b32 v24, v167, v163, s56
  v_perm_b32 v25, v175, v171, s56
  v_perm_b32 v26, v183, v179, s56
  v_perm_b32 v27, v191, v187, s56
  v_mfma_f32_16x16x32_bf16 v[52:55], v[20:23], v[12:15], v[52:55]
  v_perm_b32 v28, v167, v163, s57
  v_perm_b32 v29, v175, v171, s57
  v_perm_b32 v30, v183, v179, s57
  v_perm_b32 v31, v191, v187, s57
  v_mfma_f32_16x16x32_bf16 v[56:59], v[24:27], v[12:15], v[56:59]
  s_nop 0
  v_mfma_f32_16x16x32_bf16 v[60:63], v[28:31], v[12:15], v[60:63]
  s_cmp_lg_u32 s55, 0
  s_cbranch_scc1 L_dr1
  s_mov_b64 exec, 1
  ds_add_rtn_u32 v16, v6, v7 offset:2056
  ds_read_b32 v17, v6 offset:2128
  s_mov_b64 exec, -1
  s_waitcnt lgkmcnt(0)
  v_readfirstlane_b32 s34, v16
  v_readfirstlane_b32 s54, v17
  s_cmp_ge_u32 s34, 32
  s_cselect_b32 s34, s30, s34
  s_cselect_b32 s64, 4, 0
  s_add_u32 s30, s30, s64
  s_bfe_u32 s64, s34, 0x10000
  s_lshl_b32 s64, s64, 12
  s_or_b32 s60, s39, s64
  s_bfe_u32 s64, s34, 0x10001
  s_lshl_b32 s64, s64, 14
  s_or_b32 s60, s60, s64
  s_bfe_u32 s64, s34, 0x30002
  s_lshl_b32 s64, s64, 17
  s_or_b32 s60, s60, s64
  s_cmp_ge_u32 s34, s54
  s_cbranch_scc1 L_ve1
  buffer_load_dwordx2 v[128:129], v2, s[12:15], s60 offen offset:0 nt
  buffer_load_dwordx2 v[130:131], v2, s[12:15], s60 offen offset:8 nt
  buffer_load_dwordx2 v[132:133], v2, s[12:15], s60 offen offset:1024 nt
  buffer_load_dwordx2 v[134:135], v2, s[12:15], s60 offen offset:1032 nt
  buffer_load_dwordx4 v[136:139], v2, s[12:15], s60 offen offset:2048 nt
  buffer_load_dwordx4 v[140:143], v2, s[12:15], s60 offen offset:3072 nt
  s_add_u32 s60, s60, 0x2000
  buffer_load_dwordx2 v[144:145], v2, s[12:15], s60 offen offset:0 nt
  buffer_load_dwordx2 v[146:147], v2, s[12:15], s60 offen offset:8 nt
  buffer_load_dwordx4 v[148:151], v2, s[12:15], s60 offen offset:1024 nt
  buffer_load_dwordx4 v[152:155], v2, s[12:15], s60 offen offset:2048 nt
  buffer_load_dwordx4 v[156:159], v2, s[12:15], s60 offen offset:3072 nt
  s_add_u32 s60, s60, 0x6000
  buffer_load_dwordx2 v[160:161], v2, s[12:15], s60 offen offset:0 nt
  buffer_load_dwordx2 v[162:163], v2, s[12:15], s60 offen offset:8 nt
  buffer_load_dwordx2 v[164:165], v2, s[12:15], s60 offen offset:1024 nt
  buffer_load_dwordx2 v[166:167], v2, s[12:15], s60 offen offset:1032 nt
  buffer_load_dwordx4 v[168:171], v2, s[12:15], s60 offen offset:2048 nt
  buffer_load_dwordx4 v[172:175], v2, s[12:15], s60 offen offset:3072 nt
  s_add_u32 s60, s60, 0x2000
  buffer_load_dwordx2 v[176:177], v2, s[12:15], s60 offen offset:0 nt
  buffer_load_dwordx2 v[178:179], v2, s[12:15], s60 offen offset:8 nt
  buffer_load_dwordx4 v[180:183], v2, s[12:15], s60 offen offset:1024 nt
  buffer_load_dwordx4 v[184:187], v2, s[12:15], s60 offen offset:2048 nt
  buffer_load_dwordx4 v[188:191], v2, s[12:15], s60 offen offset:3072 nt
L_v2:
  s_lshl_b32 s63, s35, 9
  s_sub_u32 s63, s63, 4096
  v_add_u32 v16, s63, v3
  ds_read_b128 v[8:11], v16
  ds_read_b128 v[12:15], v16 offset:256
  s_cmp_eq_u32 s55, 2
  s_waitcnt lgkmcnt(0)
  v_lshlrev_b32 v16, 16, v8
  v_and_b32 v17, s73, v8
  v_lshlrev_b32 v18, 16, v9
  v_and_b32 v19, s73, v9
  v_lshlrev_b32 v20, 16, v10
  v_and_b32 v21, s73, v10
  v_lshlrev_b32 v22, 16, v11
  v_and_b32 v23, s73, v11
  v_lshlrev_b32 v24, 16, v12
  v_and_b32 v25, s73, v12
  v_lshlrev_b32 v26, 16, v13
  v_and_b32 v27, s73, v13
  v_lshlrev_b32 v28, 16, v14
  v_and_b32 v29, s73, v14
  v_lshlrev_b32 v30, 16, v15
  v_and_b32 v31, s73, v15
  v_fma_f32 v16, v16, s59, -v5
  v_fma_f32 v17, v17, s59, -v5
  v_fma_f32 v18, v18, s59, -v5
  v_fma_f32 v19, v19, s59, -v5
  v_fma_f32 v20, v20, s59, -v5
  v_fma_f32 v21, v21, s59, -v5
  v_fma_f32 v22, v22, s59, -v5
  v_fma_f32 v23, v23, s59, -v5
  v_fma_f32 v24, v24, s59, -v5
  v_fma_f32 v25, v25, s59, -v5
  v_fma_f32 v26, v26, s59, -v5
  v_fma_f32 v27, v27, s59, -v5
  v_fma_f32 v28, v28, s59, -v5
  v_fma_f32 v29, v29, s59, -v5
  v_fma_f32 v30, v30, s59, -v5
  v_fma_f32 v31, v31, s59, -v5
  v_exp_f32 v16, v16
  v_exp_f32 v17, v17
  v_exp_f32 v18, v18
  v_exp_f32 v19, v19
  v_exp_f32 v20, v20
  v_exp_f32 v21, v21
  v_exp_f32 v22, v22
  v_exp_f32 v23, v23
  v_exp_f32 v24, v24
  v_exp_f32 v25, v25
  v_exp_f32 v26, v26
  v_exp_f32 v27, v27
  v_exp_f32 v28, v28
  v_exp_f32 v29, v29
  v_exp_f32 v30, v30
  v_exp_f32 v31, v31
  v_cvt_pk_bf16_f32 v8, v16, v17
  v_cvt_pk_bf16_f32 v9, v18, v19
  v_cvt_pk_bf16_f32 v10, v20, v21
  v_cvt_pk_bf16_f32 v11, v22, v23
  v_cvt_pk_bf16_f32 v12, v24, v25
  v_cvt_pk_bf16_f32 v13, v26, v27
  v_cvt_pk_bf16_f32 v14, v28, v29
  v_cvt_pk_bf16_f32 v15, v30, v31
  s_waitcnt vmcnt(40)
  s_cbranch_scc0 L_w20
  s_waitcnt vmcnt(12)
L_w20:
  v_perm_b32 v16, v196, v192, s56
  v_perm_b32 v17, v204, v200, s56
  v_perm_b32 v18, v212, v208, s56
  v_perm_b32 v19, v220, v216, s56
  v_perm_b32 v20, v196, v192, s57
  v_perm_b32 v21, v204, v200, s57
  v_perm_b32 v22, v212, v208, s57
  v_perm_b32 v23, v220, v216, s57
  v_mfma_f32_16x16x32_bf16 v[32:35], v[16:19], v[8:11], v[32:35]
  v_perm_b32 v24, v197, v193, s56
  v_perm_b32 v25, v205, v201, s56
  v_perm_b32 v26, v213, v209, s56
  v_perm_b32 v27, v221, v217, s56
  v_mfma_f32_16x16x32_bf16 v[36:39], v[20:23], v[8:11], v[36:39]
  v_perm_b32 v28, v197, v193, s57
  v_perm_b32 v29, v205, v201, s57
  v_perm_b32 v30, v213, v209, s57
  v_perm_b32 v31, v221, v217, s57
  v_mfma_f32_16x16x32_bf16 v[40:43], v[24:27], v[8:11], v[40:43]
  v_perm_b32 v16, v198, v194, s56
  v_perm_b32 v17, v206, v202, s56
  v_perm_b32 v18, v214, v210, s56
  v_perm_b32 v19, v222, v218, s56
  v_mfma_f32_16x16x32_bf16 v[44:47], v[28:31], v[8:11], v[44:47]
  v_perm_b32 v20, v198, v194, s57
  v_perm_b32 v21, v206, v202, s57
  v_perm_b32 v22, v214, v210, s57
  v_perm_b32 v23, v222, v218, s57
  v_mfma_f32_16x16x32_bf16 v[48:51], v[16:19], v[8:11], v[48:51]
  v_perm_b32 v24, v199, v195, s56
  v_perm_b32 v25, v207, v203, s56
  v_perm_b32 v26, v215, v211, s56
  v_perm_b32 v27, v223, v219, s56
  v_mfma_f32_16x16x32_bf16 v[52:55], v[20:23], v[8:11], v[52:55]
  v_perm_b32 v28, v199, v195, s57
  v_perm_b32 v29, v207, v203, s57
  v_perm_b32 v30, v215, v211, s57
  v_perm_b32 v31, v223, v219, s57
  v_mfma_f32_16x16x32_bf16 v[56:59], v[24:27], v[8:11], v[56:59]
  s_nop 0
  v_mfma_f32_16x16x32_bf16 v[60:63], v[28:31], v[8:11], v[60:63]
  s_waitcnt vmcnt(32)
  s_cbranch_scc0 L_w21
  s_waitcnt vmcnt(4)
L_w21:
  v_perm_b32 v16, v228, v224, s56
  v_perm_b32 v17, v236, v232, s56
  v_perm_b32 v18, v244, v240, s56
  v_perm_b32 v19, v252, v248, s56
  v_perm_b32 v20, v228, v224, s57
  v_perm_b32 v21, v236, v232, s57
  v_perm_b32 v22, v244, v240, s57
  v_perm_b32 v23, v252, v248, s57
  v_mfma_f32_16x16x32_bf16 v[32:35], v[16:19], v[12:15], v[32:35]
  v_perm_b32 v24, v229, v225, s56
  v_perm_b32 v25, v237, v233, s56
  v_perm_b32 v26, v245, v241, s56
  v_perm_b32 v27, v253, v249, s56
  v_mfma_f32_16x16x32_bf16 v[36:39], v[20:23], v[12:15], v[36:39]
  v_perm_b32 v28, v229, v225, s57
  v_perm_b32 v29, v237, v233, s57
  v_perm_b32 v30, v245, v241, s57
  v_perm_b32 v31, v253, v249, s57
  v_mfma_f32_16x16x32_bf16 v[40:43], v[24:27], v[12:15], v[40:43]
  v_perm_b32 v16, v230, v226, s56
  v_perm_b32 v17, v238, v234, s56
  v_perm_b32 v18, v246, v242, s56
  v_perm_b32 v19, v254, v250, s56
  v_mfma_f32_16x16x32_bf16 v[44:47], v[28:31], v[12:15], v[44:47]
  v_perm_b32 v20, v230, v226, s57
  v_perm_b32 v21, v238, v234, s57
  v_perm_b32 v22, v246, v242, s57
  v_perm_b32 v23, v254, v250, s57
  v_mfma_f32_16x16x32_bf16 v[48:51], v[16:19], v[12:15], v[48:51]
  v_perm_b32 v24, v231, v227, s56
  v_perm_b32 v25, v239, v235, s56
  v_perm_b32 v26, v247, v243, s56
  v_perm_b32 v27, v255, v251, s56
  v_mfma_f32_16x16x32_bf16 v[52:55], v[20:23], v[12:15], v[52:55]
  v_perm_b32 v28, v231, v227, s57
  v_perm_b32 v29, v239, v235, s57
  v_perm_b32 v30, v247, v243, s57
  v_perm_b32 v31, v255, v251, s57
  v_mfma_f32_16x16x32_bf16 v[56:59], v[24:27], v[12:15], v[56:59]
  s_nop 0
  v_mfma_f32_16x16x32_bf16 v[60:63], v[28:31], v[12:15], v[60:63]
  s_cmp_lg_u32 s55, 0
  s_cbranch_scc1 L_dr2
  s_mov_b64 exec, 1
  ds_add_rtn_u32 v16, v6, v7 offset:2056
  ds_read_b32 v17, v6 offset:2128
  s_mov_b64 exec, -1
  s_waitcnt lgkmcnt(0)
  v_readfirstlane_b32 s35, v16
  v_readfirstlane_b32 s54, v17
  s_cmp_ge_u32 s35, 32
  s_cselect_b32 s35, s30, s35
  s_cselect_b32 s64, 4, 0
  s_add_u32 s30, s30, s64
  s_bfe_u32 s64, s35, 0x10000
  s_lshl_b32 s64, s64, 12
  s_or_b32 s60, s39, s64
  s_bfe_u32 s64, s35, 0x10001
  s_lshl_b32 s64, s64, 14
  s_or_b32 s60, s60, s64
  s_bfe_u32 s64, s35, 0x30002
  s_lshl_b32 s64, s64, 17
  s_or_b32 s60, s60, s64
  s_cmp_ge_u32 s35, s54
  s_cbranch_scc1 L_ve2
  buffer_load_dwordx2 v[192:193], v2, s[12:15], s60 offen offset:0 nt
  buffer_load_dwordx2 v[194:195], v2, s[12:15], s60 offen offset:8 nt
  buffer_load_dwordx2 v[196:197], v2, s[12:15], s60 offen offset:1024 nt
  buffer_load_dwordx2 v[198:199], v2, s[12:15], s60 offen offset:1032 nt
  buffer_load_dwordx4 v[200:203], v2, s[12:15], s60 offen offset:2048 nt
  buffer_load_dwordx4 v[204:207], v2, s[12:15], s60 offen offset:3072 nt
  s_add_u32 s60, s60, 0x2000
  buffer_load_dwordx2 v[208:209], v2, s[12:15], s60 offen offset:0 nt
  buffer_load_dwordx2 v[210:211], v2, s[12:15], s60 offen offset:8 nt
  buffer_load_dwordx4 v[212:215], v2, s[12:15], s60 offen offset:1024 nt
  buffer_load_dwordx4 v[216:219], v2, s[12:15], s60 offen offset:2048 nt
  buffer_load_dwordx4 v[220:223], v2, s[12:15], s60 offen offset:3072 nt
  s_add_u32 s60, s60, 0x6000
  buffer_load_dwordx2 v[224:225], v2, s[12:15], s60 offen offset:0 nt
  buffer_load_dwordx2 v[226:227], v2, s[12:15], s60 offen offset:8 nt
  buffer_load_dwordx2 v[228:229], v2, s[12:15], s60 offen offset:1024 nt
  buffer_load_dwordx2 v[230:231], v2, s[12:15], s60 offen offset:1032 nt
  buffer_load_dwordx4 v[232:235], v2, s[12:15], s60 offen offset:2048 nt
  buffer_load_dwordx4 v[236:239], v2, s[12:15], s60 offen offset:3072 nt
  s_add_u32 s60, s60, 0x2000
  buffer_load_dwordx2 v[240:241], v2, s[12:15], s60 offen offset:0 nt
  buffer_load_dwordx2 v[242:243], v2, s[12:15], s60 offen offset:8 nt
  buffer_load_dwordx4 v[244:247], v2, s[12:15], s60 offen offset:1024 nt
  buffer_load_dwordx4 v[248:251], v2, s[12:15], s60 offen offset:2048 nt
  buffer_load_dwordx4 v[252:255], v2, s[12:15], s60 offen offset:3072 nt
  s_branch L_v0
L_ve0:
  s_cmp_ge_u32 s33, 64
  s_cbranch_scc1 L_dr10
  buffer_load_dwordx4 v[64:67], v2, s[12:15], s60 offen offset:0 nt
  buffer_load_dwordx4 v[68:71], v2, s[12:15], s60 offen offset:1024 nt
  buffer_load_dwordx4 v[72:75], v2, s[12:15], s60 offen offset:2048 nt
  buffer_load_dwordx4 v[76:79], v2, s[12:15], s60 offen offset:3072 nt
  s_add_u32 s60, s60, 0x2000
  buffer_load_dwordx4 v[80:83], v2, s[12:15], s60 offen offset:0 nt
  buffer_load_dwordx4 v[84:87], v2, s[12:15], s60 offen offset:1024 nt
  buffer_load_dwordx4 v[88:91], v2, s[12:15], s60 offen offset:2048 nt
  buffer_load_dwordx4 v[92:95], v2, s[12:15], s60 offen offset:3072 nt
  s_add_u32 s60, s60, 0x6000
  buffer_load_dwordx4 v[96:99], v2, s[12:15], s60 offen offset:0 nt
  buffer_load_dwordx4 v[100:103], v2, s[12:15], s60 offen offset:1024 nt
  buffer_load_dwordx4 v[104:107], v2, s[12:15], s60 offen offset:2048 nt
  buffer_load_dwordx4 v[108:111], v2, s[12:15], s60 offen offset:3072 nt
  s_add_u32 s60, s60, 0x2000
  buffer_load_dwordx4 v[112:115], v2, s[12:15], s60 offen offset:0 nt
  buffer_load_dwordx4 v[116:119], v2, s[12:15], s60 offen offset:1024 nt
  buffer_load_dwordx4 v[120:123], v2, s[12:15], s60 offen offset:2048 nt
  buffer_load_dwordx4 v[124:127], v2, s[12:15], s60 offen offset:3072 nt
  s_branch L_v1
L_ve1:
  s_cmp_ge_u32 s34, 64
  s_cbranch_scc1 L_dr11
  buffer_load_dwordx4 v[128:131], v2, s[12:15], s60 offen offset:0 nt
  buffer_load_dwordx4 v[132:135], v2, s[12:15], s60 offen offset:1024 nt
  buffer_load_dwordx4 v[136:139], v2, s[12:15], s60 offen offset:2048 nt
  buffer_load_dwordx4 v[140:143], v2, s[12:15], s60 offen offset:3072 nt
  s_add_u32 s60, s60, 0x2000
  buffer_load_dwordx4 v[144:147], v2, s[12:15], s60 offen offset:0 nt
  buffer_load_dwordx4 v[148:151], v2, s[12:15], s60 offen offset:1024 nt
  buffer_load_dwordx4 v[152:155], v2, s[12:15], s60 offen offset:2048 nt
  buffer_load_dwordx4 v[156:159], v2, s[12:15], s60 offen offset:3072 nt
  s_add_u32 s60, s60, 0x6000
  buffer_load_dwordx4 v[160:163], v2, s[12:15], s60 offen offset:0 nt
  buffer_load_dwordx4 v[164:167], v2, s[12:15], s60 offen offset:1024 nt
  buffer_load_dwordx4 v[168:171], v2, s[12:15], s60 offen offset:2048 nt
  buffer_load_dwordx4 v[172:175], v2, s[12:15], s60 offen offset:3072 nt
  s_add_u32 s60, s60, 0x2000
  buffer_load_dwordx4 v[176:179], v2, s[12:15], s60 offen offset:0 nt
  buffer_load_dwordx4 v[180:183], v2, s[12:15], s60 offen offset:1024 nt
  buffer_load_dwordx4 v[184:187], v2, s[12:15], s60 offen offset:2048 nt
  buffer_load_dwordx4 v[188:191], v2, s[12:15], s60 offen offset:3072 nt
  s_branch L_v2
L_ve2:
  s_cmp_ge_u32 s35, 64
  s_cbranch_scc1 L_dr12
  buffer_load_dwordx4 v[192:195], v2, s[12:15], s60 offen offset:0 nt
  buffer_load_dwordx4 v[196:199], v2, s[12:15], s60 offen offset:1024 nt
  buffer_load_dwordx4 v[200:203], v2, s[12:15], s60 offen offset:2048 nt
  buffer_load_dwordx4 v[204:207], v2, s[12:15], s60 offen offset:3072 nt
  s_add_u32 s60, s60, 0x2000
  buffer_load_dwordx4 v[208:211], v2, s[12:15], s60 offen offset:0 nt
  buffer_load_dwordx4 v[212:215], v2, s[12:15], s60 offen offset:1024 nt
  buffer_load_dwordx4 v[216:219], v2, s[12:15], s60 offen offset:2048 nt
  buffer_load_dwordx4 v[220:223], v2, s[12:15], s60 offen offset:3072 nt
  s_add_u32 s60, s60, 0x6000
  buffer_load_dwordx4 v[224:227], v2, s[12:15], s60 offen offset:0 nt
  buffer_load_dwordx4 v[228:231], v2, s[12:15], s60 offen offset:1024 nt
  buffer_load_dwordx4 v[232:235], v2, s[12:15], s60 offen offset:2048 nt
  buffer_load_dwordx4 v[236:239], v2, s[12:15], s60 offen offset:3072 nt
  s_add_u32 s60, s60, 0x2000
  buffer_load_dwordx4 v[240:243], v2, s[12:15], s60 offen offset:0 nt
  buffer_load_dwordx4 v[244:247], v2, s[12:15], s60 offen offset:1024 nt
  buffer_load_dwordx4 v[248:251], v2, s[12:15], s60 offen offset:2048 nt
  buffer_load_dwordx4 v[252:255], v2, s[12:15], s60 offen offset:3072 nt
  s_branch L_v0
L_dr0:
  s_cmp_eq_u32 s55, 2
  s_cbranch_scc1 L_tail
  s_mov_b32 s55, 2
  s_branch L_v1
L_dr10:
  s_mov_b32 s67, 1
  s_branch L_drain
L_dr1:
  s_cmp_eq_u32 s55, 2
  s_cbranch_scc1 L_tail
  s_mov_b32 s55, 2
  s_branch L_v2
L_dr11:
  s_mov_b32 s67, 2
  s_branch L_drain
L_dr2:
  s_cmp_eq_u32 s55, 2
  s_cbranch_scc1 L_tail
  s_mov_b32 s55, 2
  s_branch L_v0
L_dr12:
  s_mov_b32 s67, 0
L_drain:
  v_lshrrev_b32 v16, 3, v0
  v_lshlrev_b32 v16, 13, v16
  v_and_b32 v17, 7, v0
  v_lshl_add_u32 v16, v17, 4, v16
  v_and_b32 v17, 16, v0
  v_lshlrev_b32 v17, 1, v17
  s_and_b32 s63, s74, 1
  s_lshl_b32 s63, s63, 6
  v_bitop3_b32 v16, v16, v17, s63 bitop3:0x96
  buffer_load_dwordx4 v16, s[20:23], s28 offen offset:0 nt lds
  buffer_load_dwordx4 v16, s[20:23], s28 offen offset:1024 nt lds
  buffer_load_dwordx4 v16, s[20:23], s29 offen offset:2048 nt lds
  buffer_load_dwordx4 v16, s[20:23], s29 offen offset:3072 nt lds
  v_lshrrev_b32 v1, 4, v0
  v_lshlrev_b32 v1, 4, v1
  v_mul_u32_u24 v17, 132, v4
  s_mul_i32 s63, s74, 2112
  v_add3_u32 v1, v1, v17, s63
  s_mov_b32 s55, 1
  s_waitcnt vmcnt(20)
  s_cmp_eq_u32 s67, 1
  s_cbranch_scc1 L_v1
  s_cmp_eq_u32 s67, 2
  s_cbranch_scc1 L_v2
  s_branch L_v0
L_tail:
  s_lshl_b32 s63, s74, 2
  v_mov_b32 v10, s63
  v_and_b32 v8, 31, v0
  s_mul_i32 s64, s74, 528
  v_lshl_add_u32 v8, v8, 4, s64
  v_lshlrev_b32 v9, 1, v10
  s_mov_b64 exec, s[68:69]
  ds_write_b128 v1, v[32:35] offset:3072
  ds_write_b128 v1, v[36:39] offset:3136
  ds_write_b128 v1, v[40:43] offset:3200
  ds_write_b128 v1, v[44:47] offset:3264
  ds_write_b128 v1, v[48:51] offset:3328
  ds_write_b128 v1, v[52:55] offset:3392
  ds_write_b128 v1, v[56:59] offset:3456
  ds_write_b128 v1, v[60:63] offset:3520
  s_waitcnt vmcnt(0)
  ds_write_b32 v10, v7 offset:2080
  s_mov_b64 exec, -1
  ds_read_b128 v[80:83], v6 offset:2080
  ds_read_b64 v[84:85], v9 offset:2096
  ds_read_b128 v[64:67], v8 offset:3072
  ds_read_b128 v[68:71], v8 offset:5184
  ds_read_b128 v[72:75], v8 offset:7296
  ds_read_b128 v[76:79], v8 offset:9408
  v_mov_b32 v11, 0xff
  v_lshrrev_b32 v12, 3, v0
  v_lshlrev_b32 v12, 14, v12
  v_and_b32 v14, 7, v0
  v_lshl_add_u32 v12, v14, 4, v12
  v_lshrrev_b32 v13, 4, v0
  v_bfe_u32 v16, v0, 2, 2
  v_lshlrev_b32 v16, 7, v16
  v_lshl_add_u32 v16, v4, 1, v16
  v_lshl_add_u32 v16, v13, 12, v16
  v_bfe_u32 v14, v0, 3, 2
  v_lshl_add_u32 v16, v14, 5, v16
  v_xor_b32 v17, 32, v16
  v_xor_b32 v18, 64, v16
  v_xor_b32 v19, 96, v16
  s_mov_b32 s68, -1
  s_mov_b32 s69, 0
  s_mov_b32 s72, 0
L_join:
  s_waitcnt lgkmcnt(4)
  v_min3_u32 v14, v80, v81, v82
  v_min3_u32 v14, v14, v83, v85
  v_cmp_eq_u32 vcc, 0, v14
  s_waitcnt lgkmcnt(0)
  s_cbranch_vccz L_joined
  ds_read_b128 v[80:83], v6 offset:2080
  ds_read_b64 v[84:85], v9 offset:2096
  ds_read_b128 v[64:67], v8 offset:3072
  ds_read_b128 v[68:71], v8 offset:5184
  ds_read_b128 v[72:75], v8 offset:7296
  ds_read_b128 v[76:79], v8 offset:9408
  s_add_u32 s72, s72, 1
  s_cmp_lt_u32 s72, 0x400000
  s_cbranch_scc1 L_join
  s_waitcnt lgkmcnt(0)
L_joined:
  v_add_f32 v64, v64, v68
  v_add_f32 v72, v72, v76
  v_add_f32 v65, v65, v69
  v_add_f32 v73, v73, v77
  v_add_f32 v66, v66, v70
  v_add_f32 v74, v74, v78
  v_add_f32 v67, v67, v71
  v_add_f32 v75, v75, v79
  v_add_f32 v64, v64, v72
  v_add_f32 v65, v65, v73
  v_add_f32 v66, v66, v74
  v_add_f32 v67, v67, v75
  v_mul_f32 v64, v84, v64
  v_mul_f32 v65, v84, v65
  v_mul_f32 v66, v84, v66
  v_mul_f32 v67, v84, v67
  v_add_u32 v64, 0x80, v64
  v_bfi_b32 v64, v11, s75, v64
  v_add_u32 v65, 0x80, v65
  v_bfi_b32 v65, v11, s75, v65
  v_add_u32 v66, 0x80, v66
  v_bfi_b32 v66, v11, s75, v66
  v_add_u32 v67, 0x80, v67
  v_bfi_b32 v67, v11, s75, v67
  s_mov_b64 exec, s[68:69]
  s_cmp_eq_u32 s53, 1
  s_cbranch_scc0 L_slp
  buffer_store_dwordx4 v[64:67], v2, s[16:19], s36 offen
  s_branch L_sdp
L_slp:
  buffer_store_dwordx4 v[64:67], v2, s[16:19], s36 offen sc1
L_sdp:
  s_mov_b64 exec, -1
  s_mov_b32 s72, 0
  buffer_load_dwordx4 v[88:91], v12, s[16:19], s37 offen offset:0 sc1
  buffer_load_dwordx4 v[92:95], v12, s[16:19], s37 offen offset:128 sc1
  buffer_load_dwordx4 v[96:99], v12, s[16:19], s37 offen offset:256 sc1
  buffer_load_dwordx4 v[100:103], v12, s[16:19], s37 offen offset:384 sc1
  ds_read_b64_tr_b16 v[128:129], v16 offset:45056
  ds_read_b64_tr_b16 v[130:131], v16 offset:45568
  ds_read_b64_tr_b16 v[132:133], v17 offset:45056
  ds_read_b64_tr_b16 v[134:135], v17 offset:45568
  ds_read_b64_tr_b16 v[136:137], v18 offset:45056
  ds_read_b64_tr_b16 v[138:139], v18 offset:45568
  ds_read_b64_tr_b16 v[140:141], v19 offset:45056
  ds_read_b64_tr_b16 v[142:143], v19 offset:45568
  ds_read_b64_tr_b16 v[144:145], v16 offset:47104
  ds_read_b64_tr_b16 v[146:147], v16 offset:47616
  ds_read_b64_tr_b16 v[148:149], v17 offset:47104
  ds_read_b64_tr_b16 v[150:151], v17 offset:47616
  ds_read_b64_tr_b16 v[152:153], v18 offset:47104
  ds_read_b64_tr_b16 v[154:155], v18 offset:47616
  ds_read_b64_tr_b16 v[156:157], v19 offset:47104
  ds_read_b64_tr_b16 v[158:159], v19 offset:47616
  ds_read_b64_tr_b16 v[160:161], v16 offset:46080
  ds_read_b64_tr_b16 v[162:163], v16 offset:46592
  ds_read_b64_tr_b16 v[164:165], v17 offset:46080
  ds_read_b64_tr_b16 v[166:167], v17 offset:46592
  ds_read_b64_tr_b16 v[168:169], v18 offset:46080
  ds_read_b64_tr_b16 v[170:171], v18 offset:46592
  ds_read_b64_tr_b16 v[172:173], v19 offset:46080
  ds_read_b64_tr_b16 v[174:175], v19 offset:46592
  ds_read_b64_tr_b16 v[176:177], v16 offset:48128
  ds_read_b64_tr_b16 v[178:179], v16 offset:48640
  ds_read_b64_tr_b16 v[180:181], v17 offset:48128
  ds_read_b64_tr_b16 v[182:183], v17 offset:48640
  ds_read_b64_tr_b16 v[184:185], v18 offset:48128
  ds_read_b64_tr_b16 v[186:187], v18 offset:48640
  ds_read_b64_tr_b16 v[188:189], v19 offset:48128
  ds_read_b64_tr_b16 v[190:191], v19 offset:48640
  s_branch L_pw1
L_poll1:
  buffer_load_dwordx4 v[88:91], v12, s[16:19], s37 offen offset:0 sc1
  buffer_load_dwordx4 v[92:95], v12, s[16:19], s37 offen offset:128 sc1
  buffer_load_dwordx4 v[96:99], v12, s[16:19], s37 offen offset:256 sc1
  buffer_load_dwordx4 v[100:103], v12, s[16:19], s37 offen offset:384 sc1
L_pw1:
  s_waitcnt vmcnt(0)
  v_xor_b32 v88, s75, v88
  v_xor_b32 v89, s75, v89
  v_xor_b32 v90, s75, v90
  v_xor_b32 v91, s75, v91
  v_xor_b32 v92, s75, v92
  v_xor_b32 v93, s75, v93
  v_xor_b32 v94, s75, v94
  v_xor_b32 v95, s75, v95
  v_xor_b32 v96, s75, v96
  v_xor_b32 v97, s75, v97
  v_xor_b32 v98, s75, v98
  v_xor_b32 v99, s75, v99
  v_xor_b32 v100, s75, v100
  v_xor_b32 v101, s75, v101
  v_xor_b32 v102, s75, v102
  v_xor_b32 v103, s75, v103
  v_or3_b32 v104, v88, v89, v90
  v_or3_b32 v105, v91, v92, v93
  v_or3_b32 v104, v104, v94, v95
  v_or3_b32 v105, v105, v96, v97
  v_or3_b32 v104, v104, v98, v99
  v_or3_b32 v105, v105, v100, v101
  v_or3_b32 v104, v104, v102, v103
  v_or_b32 v104, v104, v105
  v_and_b32 v105, 0xff, v104
  v_cmp_ne_u32 vcc, 0, v105
  s_cbranch_vccz L_got1
  s_mov_b64 exec, vcc
  s_add_u32 s72, s72, 1
  s_cmp_lt_u32 s72, 0x40000
  s_cbranch_scc1 L_poll1
L_got1:
  s_mov_b64 exec, -1
  ds_add_u32 v6, v7 offset:2060
  v_permlane32_swap_b32 v88, v96
  v_permlane32_swap_b32 v89, v97
  v_permlane32_swap_b32 v90, v98
  v_permlane32_swap_b32 v91, v99
  v_permlane32_swap_b32 v92, v100
  v_permlane32_swap_b32 v93, v101
  v_permlane32_swap_b32 v94, v102
  v_permlane32_swap_b32 v95, v103
  v_add_f32 v88, v88, v96
  v_add_f32 v89, v89, v97
  v_add_f32 v90, v90, v98
  v_add_f32 v91, v91, v99
  v_add_f32 v92, v92, v100
  v_add_f32 v93, v93, v101
  v_add_f32 v94, v94, v102
  v_add_f32 v95, v95, v103
  v_permlane16_swap_b32 v88, v92
  v_permlane16_swap_b32 v89, v93
  v_permlane16_swap_b32 v90, v94
  v_permlane16_swap_b32 v91, v95
  v_add_f32 v88, v88, v92
  v_add_f32 v89, v89, v93
  v_add_f32 v90, v90, v94
  v_add_f32 v91, v91, v95
  v_add_f32_dpp v88, v88, v88 row_ror:8 row_mask:0xf bank_mask:0xf
  v_add_f32_dpp v89, v89, v89 row_ror:8 row_mask:0xf bank_mask:0xf
  v_add_f32_dpp v90, v90, v90 row_ror:8 row_mask:0xf bank_mask:0xf
  v_add_f32_dpp v91, v91, v91 row_ror:8 row_mask:0xf bank_mask:0xf
  v_cvt_pk_bf16_f32 v108, v88, v89
  v_cvt_pk_bf16_f32 v109, v90, v91
  s_waitcnt lgkmcnt(0)
  v_mov_b32_dpp v110, v108 row_shl:1 row_mask:0xf bank_mask:0xf bound_ctrl:0
  v_mov_b32_dpp v111, v109 row_shl:1 row_mask:0xf bank_mask:0xf bound_ctrl:0
  v_mov_b32_dpp v112, v108 row_shl:2 row_mask:0xf bank_mask:0xf bound_ctrl:0
  v_mov_b32_dpp v113, v109 row_shl:2 row_mask:0xf bank_mask:0xf bound_ctrl:0
  v_mfma_f32_16x16x32_bf16 v[32:35], v[108:111], v[128:131], 0
  v_mov_b32_dpp v114, v108 row_shl:3 row_mask:0xf bank_mask:0xf bound_ctrl:0
  v_mov_b32_dpp v115, v109 row_shl:3 row_mask:0xf bank_mask:0xf bound_ctrl:0
  v_mfma_f32_16x16x32_bf16 v[36:39], v[108:111], v[132:135], 0
  v_mov_b32_dpp v116, v108 row_shl:4 row_mask:0xf bank_mask:0xf bound_ctrl:0
  v_mov_b32_dpp v117, v109 row_shl:4 row_mask:0xf bank_mask:0xf bound_ctrl:0
  v_mfma_f32_16x16x32_bf16 v[40:43], v[108:111], v[136:139], 0
  v_mov_b32_dpp v118, v108 row_shl:5 row_mask:0xf bank_mask:0xf bound_ctrl:0
  v_mov_b32_dpp v119, v109 row_shl:5 row_mask:0xf bank_mask:0xf bound_ctrl:0
  v_mfma_f32_16x16x32_bf16 v[44:47], v[108:111], v[140:143], 0
  v_mov_b32_dpp v120, v108 row_shl:6 row_mask:0xf bank_mask:0xf bound_ctrl:0
  v_mov_b32_dpp v121, v109 row_shl:6 row_mask:0xf bank_mask:0xf bound_ctrl:0
  v_mfma_f32_16x16x32_bf16 v[32:35], v[112:115], v[144:147], v[32:35]
  v_mov_b32_dpp v122, v108 row_shl:7 row_mask:0xf bank_mask:0xf bound_ctrl:0
  v_mov_b32_dpp v123, v109 row_shl:7 row_mask:0xf bank_mask:0xf bound_ctrl:0
  v_mfma_f32_16x16x32_bf16 v[36:39], v[112:115], v[148:151], v[36:39]
  v_mfma_f32_16x16x32_bf16 v[40:43], v[112:115], v[152:155], v[40:43]
  v_mfma_f32_16x16x32_bf16 v[44:47], v[112:115], v[156:159], v[44:47]
  v_mfma_f32_16x16x32_bf16 v[32:35], v[116:119], v[160:163], v[32:35]
  v_mfma_f32_16x16x32_bf16 v[36:39], v[116:119], v[164:167], v[36:39]
  v_mfma_f32_16x16x32_bf16 v[40:43], v[116:119], v[168:171], v[40:43]
  v_mfma_f32_16x16x32_bf16 v[44:47], v[116:119], v[172:175], v[44:47]
  v_mfma_f32_16x16x32_bf16 v[32:35], v[120:123], v[176:179], v[32:35]
  v_mfma_f32_16x16x32_bf16 v[36:39], v[120:123], v[180:183], v[36:39]
  v_mfma_f32_16x16x32_bf16 v[40:43], v[120:123], v[184:187], v[40:43]
  v_mfma_f32_16x16x32_bf16 v[44:47], v[120:123], v[188:191], v[44:47]
  s_nop 0
  s_mov_b64 exec, 0xffff
  s_nop 2
  v_add_u32 v20, 0x80, v32
  v_bfi_b32 v20, v11, s75, v20
  v_add_u32 v21, 0x80, v36
  v_bfi_b32 v21, v11, s75, v21
  v_add_u32 v22, 0x80, v40
  v_bfi_b32 v22, v11, s75, v22
  v_add_u32 v23, 0x80, v44
  v_bfi_b32 v23, v11, s75, v23
  buffer_store_dwordx4 v[20:23], v2, s[16:19], s38 offen sc1
  s_mov_b64 exec, -1
  s_branch L_fin
L_helper:
  v_mov_b32 v7, 0
  v_lshlrev_b32 v8, 2, v0
  ds_write_b32 v8, v7 offset:2048
  v_mov_b32 v9, 12
  ds_write_b32 v7, v9 offset:2056
  v_mov_b32 v9, 52
  ds_write_b32 v7, v9 offset:2128
  v_and_b32 v8, 12, v8
  v_mov_b32 v9, 0xff800000
  ds_write_b32 v8, v9 offset:2064
  s_setprio 3
  s_mov_b32 s30, 0x1000
  s_mov_b32 s31, 0x20000
  s_mov_b32 s34, 0x400000
  s_mov_b32 s35, 0x20000
  s_and_b32 s52, s6, 1
  v_and_b32 v3, 3, v0
  v_lshlrev_b32 v2, 10, v3
  v_bfe_u32 v4, v0, 2, 2
  s_lshl_b32 s63, s52, 1
  v_xor_b32 v5, s63, v4
  v_lshl_add_u32 v2, v5, 6, v2
  v_lshrrev_b32 v5, 4, v0
  v_lshl_add_u32 v2, v5, 4, v2
  s_xor_b32 s56, s4, 0
  s_lshl_b32 s56, s56, 8
  s_xor_b32 s57, s4, 1
  s_lshl_b32 s57, s57, 8
  s_xor_b32 s58, s4, 2
  s_lshl_b32 s58, s58, 8
  s_xor_b32 s59, s4, 3
  s_lshl_b32 s59, s59, 8
  v_lshrrev_b32 v10, 3, v0
  v_and_b32 v11, 7, v0
  v_lshlrev_b32 v11, 4, v11
  v_lshl_add_u32 v112, v10, 13, v11
  v_add_u32 v113, 0xfc00, v112
  v_add_u32 v114, 0x1f800, v112
  v_add_u32 v115, 0x2f400, v112
  s_lshl_b32 s64, s5, 3
  s_add_u32 s64, s64, s6
  s_lshl_b32 s64, s64, 7
  s_lshl_b32 s65, s4, 20
  s_add_u32 s64, s64, s65
  s_lshl_b32 s65, s52, 19
  s_add_u32 s60, s64, s65
  s_add_u32 s61, s60, 0x40000
  s_xor_b32 s65, s65, 0x80000
  s_add_u32 s62, s64, s65
  s_add_u32 s63, s62, 0x40000
  s_mov_b32 s72, 0x1c0000
  s_mov_b32 m0, 12288
  s_waitcnt lgkmcnt(0)
  buffer_load_dwordx4 v[64:67], v2, s[28:31], s56 offen
  buffer_load_dwordx4 v[68:71], v2, s[28:31], s57 offen
  buffer_load_dwordx4 v[72:75], v2, s[28:31], s58 offen
  buffer_load_dwordx4 v[76:79], v2, s[28:31], s59 offen
  buffer_load_dword v6, v7, s[16:19], s72 offen sc1
  buffer_load_dwordx4 v112, s[32:35], s60 offen offset:0 nt lds
  buffer_load_dwordx4 v113, s[32:35], s60 offen offset:1024 nt lds
  buffer_load_dwordx4 v114, s[32:35], s60 offen offset:2048 nt lds
  buffer_load_dwordx4 v115, s[32:35], s60 offen offset:3072 nt lds
  s_add_u32 m0, m0, 4096
  s_nop 0
  buffer_load_dwordx4 v112, s[32:35], s61 offen offset:0 nt lds
  buffer_load_dwordx4 v113, s[32:35], s61 offen offset:1024 nt lds
  buffer_load_dwordx4 v114, s[32:35], s61 offen offset:2048 nt lds
  buffer_load_dwordx4 v115, s[32:35], s61 offen offset:3072 nt lds
  s_add_u32 m0, m0, 4096
  s_nop 0
  buffer_load_dwordx4 v112, s[32:35], s62 offen offset:0 nt lds
  buffer_load_dwordx4 v113, s[32:35], s62 offen offset:1024 nt lds
  buffer_load_dwordx4 v114, s[32:35], s62 offen offset:2048 nt lds
  buffer_load_dwordx4 v115, s[32:35], s62 offen offset:3072 nt lds
  s_add_u32 m0, m0, 4096
  s_nop 0
  buffer_load_dwordx4 v112, s[32:35], s63 offen offset:0 nt lds
  buffer_load_dwordx4 v113, s[32:35], s63 offen offset:1024 nt lds
  buffer_load_dwordx4 v114, s[32:35], s63 offen offset:2048 nt lds
  buffer_load_dwordx4 v115, s[32:35], s63 offen offset:3072 nt lds
  s_barrier
  s_load_dwordx2 s[40:41], s[0:1], 56
  s_mov_b32 s42, 0xe00
  s_mov_b32 s43, 0x20000
  s_load_dwordx2 s[44:45], s[0:1], 72
  s_mov_b32 s46, 0x400
  s_mov_b32 s47, 0x20000
  s_load_dwordx2 s[36:37], s[0:1], 48
  s_mov_b32 s38, 0x1c0000
  s_mov_b32 s39, 0x20000
  s_load_dwordx2 s[24:25], s[0:1], 64
  s_mov_b32 s26, 0x1c0000
  s_mov_b32 s27, 0x20000
  s_load_dwordx2 s[48:49], s[0:1], 80
  s_mov_b32 s50, 0x1000
  s_mov_b32 s51, 0x20000
  s_lshr_b32 s54, s6, 1
  s_lshl_b32 s54, s54, 3
  s_add_u32 s54, s54, s5
  v_lshlrev_b32 v10, 8, v3
  v_lshl_add_u32 v10, v4, 6, v10
  v_lshl_add_u32 v10, v5, 4, v10
  s_lshl_b32 s60, s2, 10
  s_add_u32 s61, s60, 0x40000
  s_add_u32 s62, s60, 0x80000
  v_lshlrev_b32 v9, 10, v5
  v_lshl_add_u32 v9, v4, 7, v9
  v_lshl_add_u32 v9, v3, 3, v9
  v_mov_b32 v11, 0xff
  s_mov_b32 s12, 0xf000f0
  s_mov_b32 s13, 0xf000f0
  s_mov_b32 s14, 0xf000f00
  s_mov_b32 s15, 0xf000f00
  s_mov_b32 s68, 0xf000f000
  s_mov_b32 s69, 0xf000f000
  s_waitcnt vmcnt(17)
  v_lshlrev_b32 v80, 16, v64
  v_and_b32 v81, s73, v64
  v_lshlrev_b32 v82, 16, v65
  v_and_b32 v83, s73, v65
  v_lshlrev_b32 v84, 16, v66
  v_and_b32 v85, s73, v66
  v_lshlrev_b32 v86, 16, v67
  v_and_b32 v87, s73, v67
  v_lshlrev_b32 v88, 16, v68
  v_and_b32 v89, s73, v68
  v_lshlrev_b32 v90, 16, v69
  v_and_b32 v91, s73, v69
  v_lshlrev_b32 v92, 16, v70
  v_and_b32 v93, s73, v70
  v_lshlrev_b32 v94, 16, v71
  v_and_b32 v95, s73, v71
  v_lshlrev_b32 v96, 16, v72
  v_and_b32 v97, s73, v72
  v_lshlrev_b32 v98, 16, v73
  v_and_b32 v99, s73, v73
  v_lshlrev_b32 v100, 16, v74
  v_and_b32 v101, s73, v74
  v_lshlrev_b32 v102, 16, v75
  v_and_b32 v103, s73, v75
  v_lshlrev_b32 v104, 16, v76
  v_and_b32 v105, s73, v76
  v_lshlrev_b32 v106, 16, v77
  v_and_b32 v107, s73, v77
  v_lshlrev_b32 v108, 16, v78
  v_and_b32 v109, s73, v78
  v_lshlrev_b32 v110, 16, v79
  v_and_b32 v111, s73, v79
  v_pk_add_f32 v[20:21], v[80:81], v[82:83]
  v_pk_add_f32 v[22:23], v[84:85], v[86:87]
  v_pk_add_f32 v[20:21], v[20:21], v[88:89]
  v_pk_add_f32 v[22:23], v[22:23], v[90:91]
  v_pk_add_f32 v[20:21], v[20:21], v[92:93]
  v_pk_add_f32 v[22:23], v[22:23], v[94:95]
  v_pk_add_f32 v[20:21], v[20:21], v[96:97]
  v_pk_add_f32 v[22:23], v[22:23], v[98:99]
  v_pk_add_f32 v[20:21], v[20:21], v[100:101]
  v_pk_add_f32 v[22:23], v[22:23], v[102:103]
  v_pk_add_f32 v[20:21], v[20:21], v[104:105]
  v_pk_add_f32 v[22:23], v[22:23], v[106:107]
  v_pk_add_f32 v[20:21], v[20:21], v[108:109]
  v_pk_add_f32 v[22:23], v[22:23], v[110:111]
  v_pk_add_f32 v[20:21], v[20:21], v[22:23]
  v_add_f32 v20, v20, v21
  s_nop 1
  v_add_f32_dpp v20, v20, v20 row_ror:4 row_mask:0xf bank_mask:0xf
  s_nop 1
  v_add_f32_dpp v20, v20, v20 row_ror:8 row_mask:0xf bank_mask:0xf
  v_mov_b32 v21, v20
  s_nop 1
  v_permlane16_swap_b32 v20, v21
  v_add_f32 v20, v20, v21
  v_mov_b32 v21, v20
  s_nop 1
  v_permlane32_swap_b32 v20, v21
  v_add_f32 v20, v20, v21
  v_mul_f32 v20, 0xbb000000, v20
  v_mov_b32 v21, v20
  v_pk_add_f32 v[26:27], v[80:81], v[20:21]
  v_pk_mul_f32 v[22:23], v[26:27], v[26:27]
  v_pk_add_f32 v[28:29], v[82:83], v[20:21]
  v_pk_mul_f32 v[24:25], v[28:29], v[28:29]
  v_pk_add_f32 v[26:27], v[84:85], v[20:21]
  v_pk_fma_f32 v[22:23], v[26:27], v[26:27], v[22:23]
  v_pk_add_f32 v[28:29], v[86:87], v[20:21]
  v_pk_fma_f32 v[24:25], v[28:29], v[28:29], v[24:25]
  v_pk_add_f32 v[26:27], v[88:89], v[20:21]
  v_pk_fma_f32 v[22:23], v[26:27], v[26:27], v[22:23]
  v_pk_add_f32 v[28:29], v[90:91], v[20:21]
  v_pk_fma_f32 v[24:25], v[28:29], v[28:29], v[24:25]
  v_pk_add_f32 v[26:27], v[92:93], v[20:21]
  v_pk_fma_f32 v[22:23], v[26:27], v[26:27], v[22:23]
  v_pk_add_f32 v[28:29], v[94:95], v[20:21]
  v_pk_fma_f32 v[24:25], v[28:29], v[28:29], v[24:25]
  v_pk_add_f32 v[26:27], v[96:97], v[20:21]
  v_pk_fma_f32 v[22:23], v[26:27], v[26:27], v[22:23]
  v_pk_add_f32 v[28:29], v[98:99], v[20:21]
  v_pk_fma_f32 v[24:25], v[28:29], v[28:29], v[24:25]
  v_pk_add_f32 v[26:27], v[100:101], v[20:21]
  v_pk_fma_f32 v[22:23], v[26:27], v[26:27], v[22:23]
  v_pk_add_f32 v[28:29], v[102:103], v[20:21]
  v_pk_fma_f32 v[24:25], v[28:29], v[28:29], v[24:25]
  v_pk_add_f32 v[26:27], v[104:105], v[20:21]
  v_pk_fma_f32 v[22:23], v[26:27], v[26:27], v[22:23]
  v_pk_add_f32 v[28:29], v[106:107], v[20:21]
  v_pk_fma_f32 v[24:25], v[28:29], v[28:29], v[24:25]
  v_pk_add_f32 v[26:27], v[108:109], v[20:21]
  v_pk_fma_f32 v[22:23], v[26:27], v[26:27], v[22:23]
  v_pk_add_f32 v[28:29], v[110:111], v[20:21]
  v_pk_fma_f32 v[24:25], v[28:29], v[28:29], v[24:25]
  v_pk_add_f32 v[22:23], v[22:23], v[24:25]
  v_add_f32 v22, v22, v23
  v_cvt_pk_bf16_f32 v20, v20, v20
  v_lshlrev_b32 v20, 16, v20
  s_nop 1
  v_add_f32_dpp v22, v22, v22 row_ror:4 row_mask:0xf bank_mask:0xf
  s_nop 1
  v_add_f32_dpp v22, v22, v22 row_ror:8 row_mask:0xf bank_mask:0xf
  v_mov_b32 v23, v22
  s_nop 1
  v_permlane16_swap_b32 v22, v23
  v_add_f32 v22, v22, v23
  v_mov_b32 v23, v22
  s_nop 1
  v_permlane32_swap_b32 v22, v23
  v_add_f32 v22, v22, v23
  v_mul_f32 v22, 0x3b000000, v22
  v_cvt_pk_bf16_f32 v22, v22, v22
  v_lshlrev_b32 v22, 16, v22
  v_add_f32 v22, 0x3727c5ac, v22
  v_cvt_pk_bf16_f32 v22, v22, v22
  v_lshlrev_b32 v22, 16, v22
  v_sqrt_f32 v22, v22
  v_add_f32 v80, v80, v20
  v_add_f32 v81, v81, v20
  v_add_f32 v82, v82, v20
  v_add_f32 v83, v83, v20
  v_add_f32 v84, v84, v20
  v_add_f32 v85, v85, v20
  v_add_f32 v86, v86, v20
  v_add_f32 v87, v87, v20
  v_cvt_pk_bf16_f32 v22, v22, v22
  v_lshlrev_b32 v22, 16, v22
  v_rcp_f32 v24, v22
  v_cvt_pk_bf16_f32 v48, v80, v81
  v_cvt_pk_bf16_f32 v49, v82, v83
  v_cvt_pk_bf16_f32 v50, v84, v85
  v_cvt_pk_bf16_f32 v51, v86, v87
  v_lshlrev_b32 v80, 16, v48
  v_and_b32 v81, s73, v48
  v_lshlrev_b32 v82, 16, v49
  v_and_b32 v83, s73, v49
  v_lshlrev_b32 v84, 16, v50
  v_and_b32 v85, s73, v50
  v_lshlrev_b32 v86, 16, v51
  v_and_b32 v87, s73, v51
  v_mul_f32 v88, v80, v24
  v_mul_f32 v89, v81, v24
  v_mul_f32 v90, v82, v24
  v_mul_f32 v91, v83, v24
  v_mul_f32 v92, v84, v24
  v_mul_f32 v93, v85, v24
  v_mul_f32 v94, v86, v24
  v_mul_f32 v95, v87, v24
  v_fma_f32 v80, -v88, v22, v80
  v_fma_f32 v81, -v89, v22, v81
  v_fma_f32 v82, -v90, v22, v82
  v_fma_f32 v83, -v91, v22, v83
  v_fma_f32 v84, -v92, v22, v84
  v_fma_f32 v85, -v93, v22, v85
  v_fma_f32 v86, -v94, v22, v86
  v_fma_f32 v87, -v95, v22, v87
  v_fma_f32 v80, v80, v24, v88
  v_fma_f32 v81, v81, v24, v89
  v_fma_f32 v82, v82, v24, v90
  v_fma_f32 v83, v83, v24, v91
  v_fma_f32 v84, v84, v24, v92
  v_fma_f32 v85, v85, v24, v93
  v_fma_f32 v86, v86, v24, v94
  v_fma_f32 v87, v87, v24, v95
  v_cvt_pk_bf16_f32 v48, v80, v81
  v_cvt_pk_bf16_f32 v49, v82, v83
  v_cvt_pk_bf16_f32 v50, v84, v85
  v_cvt_pk_bf16_f32 v51, v86, v87
  s_waitcnt vmcnt(16)
  v_add_u32 v6, 1, v6
  v_mov_b32_dpp v52, v48 row_ror:4 row_mask:0xf bank_mask:0xf
  v_mov_b32_dpp v53, v49 row_ror:4 row_mask:0xf bank_mask:0xf
  v_mov_b32_dpp v54, v50 row_ror:4 row_mask:0xf bank_mask:0xf
  v_mov_b32_dpp v55, v51 row_ror:4 row_mask:0xf bank_mask:0xf
  v_mov_b32_dpp v56, v48 row_ror:8 row_mask:0xf bank_mask:0xf
  v_mov_b32_dpp v57, v49 row_ror:8 row_mask:0xf bank_mask:0xf
  v_mov_b32_dpp v58, v50 row_ror:8 row_mask:0xf bank_mask:0xf
  v_mov_b32_dpp v59, v51 row_ror:8 row_mask:0xf bank_mask:0xf
  v_mov_b32_dpp v60, v48 row_ror:12 row_mask:0xf bank_mask:0xf
  v_mov_b32_dpp v61, v49 row_ror:12 row_mask:0xf bank_mask:0xf
  v_mov_b32_dpp v62, v50 row_ror:12 row_mask:0xf bank_mask:0xf
  v_mov_b32_dpp v63, v51 row_ror:12 row_mask:0xf bank_mask:0xf
  v_readfirstlane_b32 s75, v6
  s_and_b32 s75, s75, 0xff
  s_getreg_b32 s70, hwreg(HW_REG_XCC_ID)
  s_and_b32 s70, s70, 7
  s_lshl_b32 s70, s70, 5
  s_and_b32 s71, s75, 31
  s_or_b32 s70, s70, s71
  s_waitcnt vmcnt(12)
  ds_read_b64_tr_b16 v[128:129], v9 offset:12288
  ds_read_b64_tr_b16 v[130:131], v9 offset:12800
  ds_read_b64_tr_b16 v[132:133], v9 offset:12320
  ds_read_b64_tr_b16 v[134:135], v9 offset:12832
  ds_read_b64_tr_b16 v[136:137], v9 offset:12352
  ds_read_b64_tr_b16 v[138:139], v9 offset:12864
  ds_read_b64_tr_b16 v[140:141], v9 offset:12384
  ds_read_b64_tr_b16 v[142:143], v9 offset:12896
  s_waitcnt lgkmcnt(0)
  v_mfma_f32_16x16x32_bf16 v[32:35], v[128:131], v[48:51], 0
  v_mfma_f32_16x16x32_bf16 v[36:39], v[132:135], v[52:55], 0
  v_mfma_f32_16x16x32_bf16 v[40:43], v[136:139], v[56:59], 0
  v_mfma_f32_16x16x32_bf16 v[44:47], v[140:143], v[60:63], 0
  s_waitcnt vmcnt(8)
  ds_read_b64_tr_b16 v[144:145], v9 offset:16384
  ds_read_b64_tr_b16 v[146:147], v9 offset:16896
  ds_read_b64_tr_b16 v[148:149], v9 offset:16416
  ds_read_b64_tr_b16 v[150:151], v9 offset:16928
  ds_read_b64_tr_b16 v[152:153], v9 offset:16448
  ds_read_b64_tr_b16 v[154:155], v9 offset:16960
  ds_read_b64_tr_b16 v[156:157], v9 offset:16480
  ds_read_b64_tr_b16 v[158:159], v9 offset:16992
  s_waitcnt lgkmcnt(0)
  v_mfma_f32_16x16x32_bf16 v[32:35], v[144:147], v[60:63], v[32:35]
  v_mfma_f32_16x16x32_bf16 v[36:39], v[148:151], v[48:51], v[36:39]
  v_mfma_f32_16x16x32_bf16 v[40:43], v[152:155], v[52:55], v[40:43]
  v_mfma_f32_16x16x32_bf16 v[44:47], v[156:159], v[56:59], v[44:47]
  s_waitcnt vmcnt(4)
  ds_read_b64_tr_b16 v[160:161], v9 offset:20480
  ds_read_b64_tr_b16 v[162:163], v9 offset:20992
  ds_read_b64_tr_b16 v[164:165], v9 offset:20512
  ds_read_b64_tr_b16 v[166:167], v9 offset:21024
  ds_read_b64_tr_b16 v[168:169], v9 offset:20544
  ds_read_b64_tr_b16 v[170:171], v9 offset:21056
  ds_read_b64_tr_b16 v[172:173], v9 offset:20576
  ds_read_b64_tr_b16 v[174:175], v9 offset:21088
  s_waitcnt lgkmcnt(0)
  v_mfma_f32_16x16x32_bf16 v[32:35], v[160:163], v[56:59], v[32:35]
  v_mfma_f32_16x16x32_bf16 v[36:39], v[164:167], v[60:63], v[36:39]
  v_mfma_f32_16x16x32_bf16 v[40:43], v[168:171], v[48:51], v[40:43]
  v_mfma_f32_16x16x32_bf16 v[44:47], v[172:175], v[52:55], v[44:47]
  s_waitcnt vmcnt(0)
  ds_read_b64_tr_b16 v[176:177], v9 offset:24576
  ds_read_b64_tr_b16 v[178:179], v9 offset:25088
  ds_read_b64_tr_b16 v[180:181], v9 offset:24608
  ds_read_b64_tr_b16 v[182:183], v9 offset:25120
  ds_read_b64_tr_b16 v[184:185], v9 offset:24640
  ds_read_b64_tr_b16 v[186:187], v9 offset:25152
  ds_read_b64_tr_b16 v[188:189], v9 offset:24672
  ds_read_b64_tr_b16 v[190:191], v9 offset:25184
  s_waitcnt lgkmcnt(0)
  v_mfma_f32_16x16x32_bf16 v[32:35], v[176:179], v[52:55], v[32:35]
  v_mfma_f32_16x16x32_bf16 v[36:39], v[180:183], v[56:59], v[36:39]
  v_mfma_f32_16x16x32_bf16 v[40:43], v[184:187], v[60:63], v[40:43]
  v_mfma_f32_16x16x32_bf16 v[44:47], v[188:191], v[48:51], v[44:47]
  s_nop 5
  v_cndmask_b32 v32, v32, v36, s[12:13]
  v_cndmask_b32 v33, v33, v37, s[12:13]
  v_cndmask_b32 v34, v34, v38, s[12:13]
  v_cndmask_b32 v35, v35, v39, s[12:13]
  v_cndmask_b32 v32, v32, v40, s[14:15]
  v_cndmask_b32 v33, v33, v41, s[14:15]
  v_cndmask_b32 v34, v34, v42, s[14:15]
  v_cndmask_b32 v35, v35, v43, s[14:15]
  v_cndmask_b32 v32, v32, v44, s[68:69]
  v_cndmask_b32 v33, v33, v45, s[68:69]
  v_cndmask_b32 v34, v34, v46, s[68:69]
  v_cndmask_b32 v35, v35, v47, s[68:69]
  v_add_u32 v20, 0x80, v32
  v_bfi_b32 v20, v11, s70, v20
  v_add_u32 v21, 0x80, v33
  v_bfi_b32 v21, v11, s70, v21
  v_add_u32 v22, 0x80, v34
  v_bfi_b32 v22, v11, s70, v22
  v_add_u32 v23, 0x80, v35
  v_bfi_b32 v23, v11, s70, v23
  buffer_store_dwordx4 v[20:23], v10, s[16:19], s60 offen
  v_mov_b32 v125, s75
  ds_write_b32 v7, v125 offset:2048
  v_and_b32 v14, 1, v4
  v_lshlrev_b32 v14, 6, v14
  v_lshl_add_u32 v14, v5, 4, v14
  s_lshl_b32 s8, s54, 7
  v_and_b32 v15, 1, v0
  v_lshlrev_b32 v15, 1, v15
  v_lshl_add_u32 v15, v5, 5, v15
  s_lshl_b32 s9, s5, 7
  s_lshl_b32 s66, s6, 2
  s_add_u32 s9, s9, s66
  s_lshl_b32 s53, s4, 10
  s_add_u32 s53, s53, s9
  v_lshrrev_b32 v12, 1, v4
  v_lshlrev_b32 v12, 17, v12
  v_lshl_add_u32 v12, v3, 8, v12
  v_lshl_add_u32 v12, v14, 1, v12
  s_and_b32 s56, s2, 0x37
  s_lshl_b32 s56, s56, 10
  s_add_u32 s56, s56, 0x40000
  s_add_u32 s57, s56, 0x2000
  s_add_u32 s58, s56, 0x10000
  s_add_u32 s59, s56, 0x12000
  v_lshrrev_b32 v30, 3, v0
  v_and_b32 v1, 7, v0
  v_lshlrev_b32 v1, 4, v1
  v_mul_u32_u24 v116, 3584, v30
  v_add_u32 v116, v116, v1
  v_lshl_add_u32 v120, v30, 10, v1
  v_add_u32 v117, 0x6c00, v116
  v_add_u32 v118, 0xd800, v116
  v_add_u32 v119, 0x14400, v116
  v_add_u32 v121, 0x1c00, v120
  v_add_u32 v122, 0x3800, v120
  v_add_u32 v123, 0x5400, v120
  v_lshlrev_b32 v1, 10, v30
  v_lshl_add_u32 v1, v3, 4, v1
  s_lshl_b32 s67, s4, 1
  s_add_u32 s67, s67, s52
  s_mul_i32 s64, s67, 229376
  s_add_u32 s64, s64, s8
  s_lshl_b32 s66, s54, 16
  s_lshl_b32 s67, s67, 7
  s_add_u32 s66, s66, s67
  s_add_u32 s65, s64, 114688
  s_add_u32 s67, s66, 32768
  s_mov_b32 m0, 28672
  buffer_load_ushort v28, v15, s[28:31], s53 offen
  buffer_load_ushort v29, v15, s[44:47], s9 offen
  s_cmp_ge_u32 s54, 28
  s_cbranch_scc1 L_noffn0
  buffer_load_dwordx4 v[16:19], v14, s[40:43], s8 offen
  buffer_load_dwordx4 v116, s[36:39], s64 offen offset:0 nt lds
  buffer_load_dwordx4 v117, s[36:39], s64 offen offset:1024 nt lds
  buffer_load_dwordx4 v118, s[36:39], s64 offen offset:2048 nt lds
  buffer_load_dwordx4 v119, s[36:39], s64 offen offset:3072 nt lds
  s_add_u32 m0, m0, 4096
  s_nop 0
  buffer_load_dwordx4 v116, s[36:39], s65 offen offset:0 nt lds
  buffer_load_dwordx4 v117, s[36:39], s65 offen offset:1024 nt lds
  buffer_load_dwordx4 v118, s[36:39], s65 offen offset:2048 nt lds
  buffer_load_dwordx4 v119, s[36:39], s65 offen offset:3072 nt lds
  s_add_u32 m0, m0, 4096
  s_nop 0
  s_waitcnt vmcnt(4)
  ds_read_b64_tr_b16 v[128:129], v9 offset:28672
  ds_read_b64_tr_b16 v[130:131], v9 offset:29184
  ds_read_b64_tr_b16 v[132:133], v9 offset:28704
  ds_read_b64_tr_b16 v[134:135], v9 offset:29216
  ds_read_b64_tr_b16 v[136:137], v9 offset:28736
  ds_read_b64_tr_b16 v[138:139], v9 offset:29248
  ds_read_b64_tr_b16 v[140:141], v9 offset:28768
  ds_read_b64_tr_b16 v[142:143], v9 offset:29280
  s_waitcnt lgkmcnt(0)
  v_mfma_f32_16x16x32_bf16 v[32:35], v[128:131], v[48:51], 0
  v_mfma_f32_16x16x32_bf16 v[36:39], v[132:135], v[52:55], 0
  v_mfma_f32_16x16x32_bf16 v[40:43], v[136:139], v[56:59], 0
  v_mfma_f32_16x16x32_bf16 v[44:47], v[140:143], v[60:63], 0
  s_waitcnt vmcnt(0)
  ds_read_b64_tr_b16 v[144:145], v9 offset:32768
  ds_read_b64_tr_b16 v[146:147], v9 offset:33280
  ds_read_b64_tr_b16 v[148:149], v9 offset:32800
  ds_read_b64_tr_b16 v[150:151], v9 offset:33312
  ds_read_b64_tr_b16 v[152:153], v9 offset:32832
  ds_read_b64_tr_b16 v[154:155], v9 offset:33344
  ds_read_b64_tr_b16 v[156:157], v9 offset:32864
  ds_read_b64_tr_b16 v[158:159], v9 offset:33376
  s_waitcnt lgkmcnt(0)
  v_mfma_f32_16x16x32_bf16 v[32:35], v[144:147], v[60:63], v[32:35]
  v_mfma_f32_16x16x32_bf16 v[36:39], v[148:151], v[48:51], v[36:39]
  v_mfma_f32_16x16x32_bf16 v[40:43], v[152:155], v[52:55], v[40:43]
  v_mfma_f32_16x16x32_bf16 v[44:47], v[156:159], v[56:59], v[44:47]
  s_nop 5
  v_cndmask_b32 v32, v32, v36, s[12:13]
  v_cndmask_b32 v33, v33, v37, s[12:13]
  v_cndmask_b32 v34, v34, v38, s[12:13]
  v_cndmask_b32 v35, v35, v39, s[12:13]
  v_cndmask_b32 v32, v32, v40, s[14:15]
  v_cndmask_b32 v33, v33, v41, s[14:15]
  v_cndmask_b32 v34, v34, v42, s[14:15]
  v_cndmask_b32 v35, v35, v43, s[14:15]
  v_cndmask_b32 v32, v32, v44, s[68:69]
  v_cndmask_b32 v33, v33, v45, s[68:69]
  v_cndmask_b32 v34, v34, v46, s[68:69]
  v_cndmask_b32 v35, v35, v47, s[68:69]
  v_add_u32 v24, 0x80, v32
  v_bfi_b32 v24, v11, s75, v24
  v_add_u32 v25, 0x80, v33
  v_bfi_b32 v25, v11, s75, v25
  v_add_u32 v26, 0x80, v34
  v_bfi_b32 v26, v11, s75, v26
  v_add_u32 v27, 0x80, v35
  v_bfi_b32 v27, v11, s75, v27
L_noffn0:
  v_lshrrev_b32 v124, 3, v0
  v_lshlrev_b32 v124, 13, v124
  v_and_b32 v13, 7, v0
  v_lshl_add_u32 v124, v13, 5, v124
  s_lshl_b32 s20, s5, 10
  s_lshl_b32 s63, s4, 8
  s_add_u32 s20, s20, s63
  s_add_u32 s21, s20, 0x10000
  s_add_u32 s22, s20, 0x20000
  s_add_u32 s23, s20, 0x30000
  v_lshlrev_b32 v13, 4, v0
  s_mov_b32 s72, 0
L_pollq:
  buffer_load_dwordx4 v[64:67], v124, s[16:19], s20 offen offset:0 sc1
  buffer_load_dwordx4 v[68:71], v124, s[16:19], s20 offen offset:16 sc1
  buffer_load_dwordx4 v[72:75], v124, s[16:19], s21 offen offset:0 sc1
  buffer_load_dwordx4 v[76:79], v124, s[16:19], s21 offen offset:16 sc1
  buffer_load_dwordx4 v[80:83], v124, s[16:19], s22 offen offset:0 sc1
  buffer_load_dwordx4 v[84:87], v124, s[16:19], s22 offen offset:16 sc1
  buffer_load_dwordx4 v[88:91], v124, s[16:19], s23 offen offset:0 sc1
  buffer_load_dwordx4 v[92:95], v124, s[16:19], s23 offen offset:16 sc1
  s_waitcnt vmcnt(0)
  v_xor_b32 v64, s70, v64
  v_xor_b32 v65, s70, v65
  v_xor_b32 v66, s70, v66
  v_xor_b32 v67, s70, v67
  v_xor_b32 v68, s70, v68
  v_xor_b32 v69, s70, v69
  v_xor_b32 v70, s70, v70
  v_xor_b32 v71, s70, v71
  v_xor_b32 v72, s70, v72
  v_xor_b32 v73, s70, v73
  v_xor_b32 v74, s70, v74
  v_xor_b32 v75, s70, v75
  v_xor_b32 v76, s70, v76
  v_xor_b32 v77, s70, v77
  v_xor_b32 v78, s70, v78
  v_xor_b32 v79, s70, v79
  v_xor_b32 v80, s70, v80
  v_xor_b32 v81, s70, v81
  v_xor_b32 v82, s70, v82
  v_xor_b32 v83, s70, v83
  v_xor_b32 v84, s70, v84
  v_xor_b32 v85, s70, v85
  v_xor_b32 v86, s70, v86
  v_xor_b32 v87, s70, v87
  v_xor_b32 v88, s70, v88
  v_xor_b32 v89, s70, v89
  v_xor_b32 v90, s70, v90
  v_xor_b32 v91, s70, v91
  v_xor_b32 v92, s70, v92
  v_xor_b32 v93, s70, v93
  v_xor_b32 v94, s70, v94
  v_xor_b32 v95, s70, v95
  v_or3_b32 v30, v64, v65, v66
  v_or3_b32 v31, v67, v68, v69
  v_or3_b32 v30, v30, v70, v71
  v_or3_b32 v31, v31, v72, v73
  v_or3_b32 v30, v30, v74, v75
  v_or3_b32 v31, v31, v76, v77
  v_or3_b32 v30, v30, v78, v79
  v_or3_b32 v31, v31, v80, v81
  v_or3_b32 v30, v30, v82, v83
  v_or3_b32 v31, v31, v84, v85
  v_or3_b32 v30, v30, v86, v87
  v_or3_b32 v31, v31, v88, v89
  v_or3_b32 v30, v30, v90, v91
  v_or3_b32 v31, v31, v92, v93
  v_or3_b32 v30, v30, v94, v95
  v_or_b32 v30, v30, v31
  v_and_b32 v31, 0x1f, v30
  v_cmp_ne_u32 vcc, 0, v31
  s_cbranch_vccz L_gotq
  s_add_u32 s72, s72, 1
  s_cmp_lg_u32 s72, 3
  s_cbranch_scc1 L_norp
  s_mov_b64 exec, -1
  buffer_store_dwordx4 v[20:23], v10, s[16:19], s60 offen sc1
L_norp:
  s_mov_b64 exec, vcc
  s_sleep 4
  s_cmp_lt_u32 s72, 0x40000
  s_cbranch_scc1 L_pollq
L_gotq:
  s_mov_b64 exec, -1
  v_and_b32 v30, 0xe0, v30
  v_cmp_ne_u32 vcc, 0, v30
  v_mov_b32 v31, 1
  s_cbranch_vccz L_same
  v_mov_b32 v31, 2
  buffer_store_dwordx4 v[20:23], v10, s[16:19], s60 offen sc1
  v_and_b32 v64, 0xffffff00, v64
  v_and_b32 v65, 0xffffff00, v65
  v_and_b32 v66, 0xffffff00, v66
  v_and_b32 v67, 0xffffff00, v67
  v_and_b32 v68, 0xffffff00, v68
  v_and_b32 v69, 0xffffff00, v69
  v_and_b32 v70, 0xffffff00, v70
  v_and_b32 v71, 0xffffff00, v71
  v_and_b32 v72, 0xffffff00, v72
  v_and_b32 v73, 0xffffff00, v73
  v_and_b32 v74, 0xffffff00, v74
  v_and_b32 v75, 0xffffff00, v75
  v_and_b32 v76, 0xffffff00, v76
  v_and_b32 v77, 0xffffff00, v77
  v_and_b32 v78, 0xffffff00, v78
  v_and_b32 v79, 0xffffff00, v79
  v_and_b32 v80, 0xffffff00, v80
  v_and_b32 v81, 0xffffff00, v81
  v_and_b32 v82, 0xffffff00, v82
  v_and_b32 v83, 0xffffff00, v83
  v_and_b32 v84, 0xffffff00, v84
  v_and_b32 v85, 0xffffff00, v85
  v_and_b32 v86, 0xffffff00, v86
  v_and_b32 v87, 0xffffff00, v87
  v_and_b32 v88, 0xffffff00, v88
  v_and_b32 v89, 0xffffff00, v89
  v_and_b32 v90, 0xffffff00, v90
  v_and_b32 v91, 0xffffff00, v91
  v_and_b32 v92, 0xffffff00, v92
  v_and_b32 v93, 0xffffff00, v93
  v_and_b32 v94, 0xffffff00, v94
  v_and_b32 v95, 0xffffff00, v95
L_same:
  v_pk_add_f32 v[64:65], v[64:65], v[72:73]
  v_pk_add_f32 v[80:81], v[80:81], v[88:89]
  v_pk_add_f32 v[66:67], v[66:67], v[74:75]
  v_pk_add_f32 v[82:83], v[82:83], v[90:91]
  v_pk_add_f32 v[68:69], v[68:69], v[76:77]
  v_pk_add_f32 v[84:85], v[84:85], v[92:93]
  v_pk_add_f32 v[70:71], v[70:71], v[78:79]
  v_pk_add_f32 v[86:87], v[86:87], v[94:95]
  v_pk_add_f32 v[64:65], v[64:65], v[80:81]
  v_pk_add_f32 v[66:67], v[66:67], v[82:83]
  v_pk_add_f32 v[68:69], v[68:69], v[84:85]
  v_pk_add_f32 v[70:71], v[70:71], v[86:87]
  v_cvt_pk_bf16_f32 v32, v64, v65
  v_cvt_pk_bf16_f32 v33, v66, v67
  v_cvt_pk_bf16_f32 v34, v68, v69
  v_cvt_pk_bf16_f32 v35, v70, v71
  ds_write_b128 v13, v[32:35] offset:0
  ds_write_b32 v7, v31 offset:2052
  s_setprio 0
  v_readfirstlane_b32 s55, v31
  s_cmp_ge_u32 s54, 28
  s_cbranch_scc1 L_noffn1
  s_cmp_eq_u32 s55, 1
  s_cbranch_scc0 L_slh
  buffer_store_dwordx4 v[24:27], v10, s[16:19], s61 offen
  s_branch L_sdh
L_slh:
  buffer_store_dwordx4 v[24:27], v10, s[16:19], s61 offen sc1
L_sdh:
L_noffn1:
  s_load_dwordx2 s[20:21], s[0:1], 16
  s_load_dwordx2 s[22:23], s[0:1], 32
  s_lshl_b32 s63, s4, 3
  s_add_u32 s63, s63, s5
  s_lshl_b32 s63, s63, 3
  s_add_u32 s63, s63, s6
  s_lshl_b32 s63, s63, 19
  s_lshl_b32 s64, s5, 19
  s_waitcnt lgkmcnt(0)
  s_add_u32 s20, s20, s63
  s_addc_u32 s21, s21, 0
  s_add_u32 s22, s22, s64
  s_addc_u32 s23, s23, 0
  s_load_dword s10, s[20:21], 0
  s_load_dword s11, s[22:23], 0
  s_load_dword s64, s[24:25], 0
  s_waitcnt lgkmcnt(0)
  s_cmp_eq_u32 s55, 1
  s_cbranch_scc0 L_noctla
  s_lshl_b32 s64, s5, 7
  s_add_u32 s64, s64, 0x1a0000
  s_lshr_b32 s65, s2, 3
  s_lshl_b32 s65, s65, 2
  s_add_u32 s65, s65, s64
  v_and_b32 v124, 31, v0
  v_lshlrev_b32 v124, 2, v124
  s_mov_b32 s20, 18
  s_and_b32 s11, s75, 0xff
L_ctla:
  s_mov_b32 s72, 0
L_wctla:
  ds_read_b32 v30, v7 offset:2056
  s_add_u32 s72, s72, 1
  s_waitcnt lgkmcnt(0)
  v_cmp_le_u32 vcc, s20, v30
  s_cbranch_vccnz L_gctla
  s_sleep 4
  s_cmp_lt_u32 s72, 0x400000
  s_cbranch_scc1 L_wctla
L_gctla:
  s_lshl_b32 s21, s20, 8
  s_or_b32 s21, s21, s11
  v_mov_b32 v125, s21
  buffer_load_dword v126, v124, s[16:19], s64 offen sc1
  buffer_store_dword v125, v7, s[16:19], s65 offen
  s_waitcnt vmcnt(1)
  v_and_b32 v127, 0xffff00ff, v126
  v_cmp_eq_u32 vcc, s11, v127
  v_cmp_le_u32 s[70:71], v125, v126
  s_and_b32 s21, vcc_lo, s70
  s_bcnt1_i32_b32 s21, s21
  s_cmp_ge_u32 s21, 22
  s_cselect_b32 s21, 0, 52
  v_mov_b32 v127, s21
  ds_write_b32 v7, v127 offset:2128
  s_add_u32 s20, s20, 6
  s_cmp_le_u32 s20, 42
  s_cbranch_scc1 L_ctla
L_noctla:
  s_mov_b32 s72, 0
L_wkdh:
  ds_read_b32 v30, v7 offset:2060
  s_add_u32 s72, s72, 1
  s_waitcnt lgkmcnt(0)
  v_cmp_le_u32 vcc, 512, v30
  s_cbranch_vccnz L_gkdh
  s_sleep 8
  s_cmp_lt_u32 s72, 0x400000
  s_cbranch_scc1 L_wkdh
L_gkdh:
  ds_read_b32 v32, v8 offset:2064
  ds_read_b128 v[128:131], v13 offset:12288
  ds_read_b128 v[132:135], v13 offset:13312
  ds_read_b128 v[136:139], v13 offset:14336
  ds_read_b128 v[140:143], v13 offset:15360
  ds_read_b128 v[144:147], v13 offset:16384
  ds_read_b128 v[148:151], v13 offset:17408
  ds_read_b128 v[152:155], v13 offset:18432
  ds_read_b128 v[156:159], v13 offset:19456
  ds_read_b128 v[160:163], v13 offset:20480
  ds_read_b128 v[164:167], v13 offset:21504
  ds_read_b128 v[168:171], v13 offset:22528
  ds_read_b128 v[172:175], v13 offset:23552
  ds_read_b128 v[176:179], v13 offset:24576
  ds_read_b128 v[180:183], v13 offset:25600
  ds_read_b128 v[184:187], v13 offset:26624
  ds_read_b128 v[188:191], v13 offset:27648
  s_mov_b32 s10, 0x3fb8aa3b
  s_waitcnt lgkmcnt(0)
  v_cvt_pk_bf16_f32 v32, v32, v32
  v_lshlrev_b32 v32, 16, v32
  v_mul_f32 v33, s10, v32
  v_mov_b32 v34, 0
  v_mov_b32 v35, 0
  v_mov_b32 v36, 0
  v_mov_b32 v37, 0
  v_lshlrev_b32 v64, 16, v128
  v_and_b32 v65, s73, v128
  v_lshlrev_b32 v66, 16, v129
  v_and_b32 v67, s73, v129
  v_lshlrev_b32 v68, 16, v130
  v_and_b32 v69, s73, v130
  v_lshlrev_b32 v70, 16, v131
  v_and_b32 v71, s73, v131
  v_lshlrev_b32 v72, 16, v132
  v_and_b32 v73, s73, v132
  v_lshlrev_b32 v74, 16, v133
  v_and_b32 v75, s73, v133
  v_lshlrev_b32 v76, 16, v134
  v_and_b32 v77, s73, v134
  v_lshlrev_b32 v78, 16, v135
  v_and_b32 v79, s73, v135
  v_lshlrev_b32 v80, 16, v136
  v_and_b32 v81, s73, v136
  v_lshlrev_b32 v82, 16, v137
  v_and_b32 v83, s73, v137
  v_lshlrev_b32 v84, 16, v138
  v_and_b32 v85, s73, v138
  v_lshlrev_b32 v86, 16, v139
  v_and_b32 v87, s73, v139
  v_lshlrev_b32 v88, 16, v140
  v_and_b32 v89, s73, v140
  v_lshlrev_b32 v90, 16, v141
  v_and_b32 v91, s73, v141
  v_lshlrev_b32 v92, 16, v142
  v_and_b32 v93, s73, v142
  v_lshlrev_b32 v94, 16, v143
  v_and_b32 v95, s73, v143
  v_fma_f32 v64, v64, s10, -v33
  v_fma_f32 v65, v65, s10, -v33
  v_fma_f32 v66, v66, s10, -v33
  v_fma_f32 v67, v67, s10, -v33
  v_fma_f32 v68, v68, s10, -v33
  v_fma_f32 v69, v69, s10, -v33
  v_fma_f32 v70, v70, s10, -v33
  v_fma_f32 v71, v71, s10, -v33
  v_fma_f32 v72, v72, s10, -v33
  v_fma_f32 v73, v73, s10, -v33
  v_fma_f32 v74, v74, s10, -v33
  v_fma_f32 v75, v75, s10, -v33
  v_fma_f32 v76, v76, s10, -v33
  v_fma_f32 v77, v77, s10, -v33
  v_fma_f32 v78, v78, s10, -v33
  v_fma_f32 v79, v79, s10, -v33
  v_fma_f32 v80, v80, s10, -v33
  v_fma_f32 v81, v81, s10, -v33
  v_fma_f32 v82, v82, s10, -v33
  v_fma_f32 v83, v83, s10, -v33
  v_fma_f32 v84, v84, s10, -v33
  v_fma_f32 v85, v85, s10, -v33
  v_fma_f32 v86, v86, s10, -v33
  v_fma_f32 v87, v87, s10, -v33
  v_fma_f32 v88, v88, s10, -v33
  v_fma_f32 v89, v89, s10, -v33
  v_fma_f32 v90, v90, s10, -v33
  v_fma_f32 v91, v91, s10, -v33
  v_fma_f32 v92, v92, s10, -v33
  v_fma_f32 v93, v93, s10, -v33
  v_fma_f32 v94, v94, s10, -v33
  v_fma_f32 v95, v95, s10, -v33
  v_exp_f32 v64, v64
  v_exp_f32 v65, v65
  v_exp_f32 v66, v66
  v_exp_f32 v67, v67
  v_exp_f32 v68, v68
  v_exp_f32 v69, v69
  v_exp_f32 v70, v70
  v_exp_f32 v71, v71
  v_exp_f32 v72, v72
  v_exp_f32 v73, v73
  v_exp_f32 v74, v74
  v_exp_f32 v75, v75
  v_exp_f32 v76, v76
  v_exp_f32 v77, v77
  v_exp_f32 v78, v78
  v_exp_f32 v79, v79
  v_exp_f32 v80, v80
  v_exp_f32 v81, v81
  v_exp_f32 v82, v82
  v_exp_f32 v83, v83
  v_exp_f32 v84, v84
  v_exp_f32 v85, v85
  v_exp_f32 v86, v86
  v_exp_f32 v87, v87
  v_exp_f32 v88, v88
  v_exp_f32 v89, v89
  v_exp_f32 v90, v90
  v_exp_f32 v91, v91
  v_exp_f32 v92, v92
  v_exp_f32 v93, v93
  v_exp_f32 v94, v94
  v_exp_f32 v95, v95
  v_add_f32 v34, v34, v64
  v_add_f32 v35, v35, v65
  v_add_f32 v36, v36, v66
  v_add_f32 v37, v37, v67
  v_add_f32 v34, v34, v68
  v_add_f32 v35, v35, v69
  v_add_f32 v36, v36, v70
  v_add_f32 v37, v37, v71
  v_add_f32 v34, v34, v72
  v_add_f32 v35, v35, v73
  v_add_f32 v36, v36, v74
  v_add_f32 v37, v37, v75
  v_add_f32 v34, v34, v76
  v_add_f32 v35, v35, v77
  v_add_f32 v36, v36, v78
  v_add_f32 v37, v37, v79
  v_add_f32 v34, v34, v80
  v_add_f32 v35, v35, v81
  v_add_f32 v36, v36, v82
  v_add_f32 v37, v37, v83
  v_add_f32 v34, v34, v84
  v_add_f32 v35, v35, v85
  v_add_f32 v36, v36, v86
  v_add_f32 v37, v37, v87
  v_add_f32 v34, v34, v88
  v_add_f32 v35, v35, v89
  v_add_f32 v36, v36, v90
  v_add_f32 v37, v37, v91
  v_add_f32 v34, v34, v92
  v_add_f32 v35, v35, v93
  v_add_f32 v36, v36, v94
  v_add_f32 v37, v37, v95
  v_lshlrev_b32 v64, 16, v144
  v_and_b32 v65, s73, v144
  v_lshlrev_b32 v66, 16, v145
  v_and_b32 v67, s73, v145
  v_lshlrev_b32 v68, 16, v146
  v_and_b32 v69, s73, v146
  v_lshlrev_b32 v70, 16, v147
  v_and_b32 v71, s73, v147
  v_lshlrev_b32 v72, 16, v148
  v_and_b32 v73, s73, v148
  v_lshlrev_b32 v74, 16, v149
  v_and_b32 v75, s73, v149
  v_lshlrev_b32 v76, 16, v150
  v_and_b32 v77, s73, v150
  v_lshlrev_b32 v78, 16, v151
  v_and_b32 v79, s73, v151
  v_lshlrev_b32 v80, 16, v152
  v_and_b32 v81, s73, v152
  v_lshlrev_b32 v82, 16, v153
  v_and_b32 v83, s73, v153
  v_lshlrev_b32 v84, 16, v154
  v_and_b32 v85, s73, v154
  v_lshlrev_b32 v86, 16, v155
  v_and_b32 v87, s73, v155
  v_lshlrev_b32 v88, 16, v156
  v_and_b32 v89, s73, v156
  v_lshlrev_b32 v90, 16, v157
  v_and_b32 v91, s73, v157
  v_lshlrev_b32 v92, 16, v158
  v_and_b32 v93, s73, v158
  v_lshlrev_b32 v94, 16, v159
  v_and_b32 v95, s73, v159
  v_fma_f32 v64, v64, s10, -v33
  v_fma_f32 v65, v65, s10, -v33
  v_fma_f32 v66, v66, s10, -v33
  v_fma_f32 v67, v67, s10, -v33
  v_fma_f32 v68, v68, s10, -v33
  v_fma_f32 v69, v69, s10, -v33
  v_fma_f32 v70, v70, s10, -v33
  v_fma_f32 v71, v71, s10, -v33
  v_fma_f32 v72, v72, s10, -v33
  v_fma_f32 v73, v73, s10, -v33
  v_fma_f32 v74, v74, s10, -v33
  v_fma_f32 v75, v75, s10, -v33
  v_fma_f32 v76, v76, s10, -v33
  v_fma_f32 v77, v77, s10, -v33
  v_fma_f32 v78, v78, s10, -v33
  v_fma_f32 v79, v79, s10, -v33
  v_fma_f32 v80, v80, s10, -v33
  v_fma_f32 v81, v81, s10, -v33
  v_fma_f32 v82, v82, s10, -v33
  v_fma_f32 v83, v83, s10, -v33
  v_fma_f32 v84, v84, s10, -v33
  v_fma_f32 v85, v85, s10, -v33
  v_fma_f32 v86, v86, s10, -v33
  v_fma_f32 v87, v87, s10, -v33
  v_fma_f32 v88, v88, s10, -v33
  v_fma_f32 v89, v89, s10, -v33
  v_fma_f32 v90, v90, s10, -v33
  v_fma_f32 v91, v91, s10, -v33
  v_fma_f32 v92, v92, s10, -v33
  v_fma_f32 v93, v93, s10, -v33
  v_fma_f32 v94, v94, s10, -v33
  v_fma_f32 v95, v95, s10, -v33
  v_exp_f32 v64, v64
  v_exp_f32 v65, v65
  v_exp_f32 v66, v66
  v_exp_f32 v67, v67
  v_exp_f32 v68, v68
  v_exp_f32 v69, v69
  v_exp_f32 v70, v70
  v_exp_f32 v71, v71
  v_exp_f32 v72, v72
  v_exp_f32 v73, v73
  v_exp_f32 v74, v74
  v_exp_f32 v75, v75
  v_exp_f32 v76, v76
  v_exp_f32 v77, v77
  v_exp_f32 v78, v78
  v_exp_f32 v79, v79
  v_exp_f32 v80, v80
  v_exp_f32 v81, v81
  v_exp_f32 v82, v82
  v_exp_f32 v83, v83
  v_exp_f32 v84, v84
  v_exp_f32 v85, v85
  v_exp_f32 v86, v86
  v_exp_f32 v87, v87
  v_exp_f32 v88, v88
  v_exp_f32 v89, v89
  v_exp_f32 v90, v90
  v_exp_f32 v91, v91
  v_exp_f32 v92, v92
  v_exp_f32 v93, v93
  v_exp_f32 v94, v94
  v_exp_f32 v95, v95
  v_add_f32 v34, v34, v64
  v_add_f32 v35, v35, v65
  v_add_f32 v36, v36, v66
  v_add_f32 v37, v37, v67
  v_add_f32 v34, v34, v68
  v_add_f32 v35, v35, v69
  v_add_f32 v36, v36, v70
  v_add_f32 v37, v37, v71
  v_add_f32 v34, v34, v72
  v_add_f32 v35, v35, v73
  v_add_f32 v36, v36, v74
  v_add_f32 v37, v37, v75
  v_add_f32 v34, v34, v76
  v_add_f32 v35, v35, v77
  v_add_f32 v36, v36, v78
  v_add_f32 v37, v37, v79
  v_add_f32 v34, v34, v80
  v_add_f32 v35, v35, v81
  v_add_f32 v36, v36, v82
  v_add_f32 v37, v37, v83
  v_add_f32 v34, v34, v84
  v_add_f32 v35, v35, v85
  v_add_f32 v36, v36, v86
  v_add_f32 v37, v37, v87
  v_add_f32 v34, v34, v88
  v_add_f32 v35, v35, v89
  v_add_f32 v36, v36, v90
  v_add_f32 v37, v37, v91
  v_add_f32 v34, v34, v92
  v_add_f32 v35, v35, v93
  v_add_f32 v36, v36, v94
  v_add_f32 v37, v37, v95
  v_lshlrev_b32 v64, 16, v160
  v_and_b32 v65, s73, v160
  v_lshlrev_b32 v66, 16, v161
  v_and_b32 v67, s73, v161
  v_lshlrev_b32 v68, 16, v162
  v_and_b32 v69, s73, v162
  v_lshlrev_b32 v70, 16, v163
  v_and_b32 v71, s73, v163
  v_lshlrev_b32 v72, 16, v164
  v_and_b32 v73, s73, v164
  v_lshlrev_b32 v74, 16, v165
  v_and_b32 v75, s73, v165
  v_lshlrev_b32 v76, 16, v166
  v_and_b32 v77, s73, v166
  v_lshlrev_b32 v78, 16, v167
  v_and_b32 v79, s73, v167
  v_lshlrev_b32 v80, 16, v168
  v_and_b32 v81, s73, v168
  v_lshlrev_b32 v82, 16, v169
  v_and_b32 v83, s73, v169
  v_lshlrev_b32 v84, 16, v170
  v_and_b32 v85, s73, v170
  v_lshlrev_b32 v86, 16, v171
  v_and_b32 v87, s73, v171
  v_lshlrev_b32 v88, 16, v172
  v_and_b32 v89, s73, v172
  v_lshlrev_b32 v90, 16, v173
  v_and_b32 v91, s73, v173
  v_lshlrev_b32 v92, 16, v174
  v_and_b32 v93, s73, v174
  v_lshlrev_b32 v94, 16, v175
  v_and_b32 v95, s73, v175
  v_fma_f32 v64, v64, s10, -v33
  v_fma_f32 v65, v65, s10, -v33
  v_fma_f32 v66, v66, s10, -v33
  v_fma_f32 v67, v67, s10, -v33
  v_fma_f32 v68, v68, s10, -v33
  v_fma_f32 v69, v69, s10, -v33
  v_fma_f32 v70, v70, s10, -v33
  v_fma_f32 v71, v71, s10, -v33
  v_fma_f32 v72, v72, s10, -v33
  v_fma_f32 v73, v73, s10, -v33
  v_fma_f32 v74, v74, s10, -v33
  v_fma_f32 v75, v75, s10, -v33
  v_fma_f32 v76, v76, s10, -v33
  v_fma_f32 v77, v77, s10, -v33
  v_fma_f32 v78, v78, s10, -v33
  v_fma_f32 v79, v79, s10, -v33
  v_fma_f32 v80, v80, s10, -v33
  v_fma_f32 v81, v81, s10, -v33
  v_fma_f32 v82, v82, s10, -v33
  v_fma_f32 v83, v83, s10, -v33
  v_fma_f32 v84, v84, s10, -v33
  v_fma_f32 v85, v85, s10, -v33
  v_fma_f32 v86, v86, s10, -v33
  v_fma_f32 v87, v87, s10, -v33
  v_fma_f32 v88, v88, s10, -v33
  v_fma_f32 v89, v89, s10, -v33
  v_fma_f32 v90, v90, s10, -v33
  v_fma_f32 v91, v91, s10, -v33
  v_fma_f32 v92, v92, s10, -v33
  v_fma_f32 v93, v93, s10, -v33
  v_fma_f32 v94, v94, s10, -v33
  v_fma_f32 v95, v95, s10, -v33
  v_exp_f32 v64, v64
  v_exp_f32 v65, v65
  v_exp_f32 v66, v66
  v_exp_f32 v67, v67
  v_exp_f32 v68, v68
  v_exp_f32 v69, v69
  v_exp_f32 v70, v70
  v_exp_f32 v71, v71
  v_exp_f32 v72, v72
  v_exp_f32 v73, v73
  v_exp_f32 v74, v74
  v_exp_f32 v75, v75
  v_exp_f32 v76, v76
  v_exp_f32 v77, v77
  v_exp_f32 v78, v78
  v_exp_f32 v79, v79
  v_exp_f32 v80, v80
  v_exp_f32 v81, v81
  v_exp_f32 v82, v82
  v_exp_f32 v83, v83
  v_exp_f32 v84, v84
  v_exp_f32 v85, v85
  v_exp_f32 v86, v86
  v_exp_f32 v87, v87
  v_exp_f32 v88, v88
  v_exp_f32 v89, v89
  v_exp_f32 v90, v90
  v_exp_f32 v91, v91
  v_exp_f32 v92, v92
  v_exp_f32 v93, v93
  v_exp_f32 v94, v94
  v_exp_f32 v95, v95
  v_add_f32 v34, v34, v64
  v_add_f32 v35, v35, v65
  v_add_f32 v36, v36, v66
  v_add_f32 v37, v37, v67
  v_add_f32 v34, v34, v68
  v_add_f32 v35, v35, v69
  v_add_f32 v36, v36, v70
  v_add_f32 v37, v37, v71
  v_add_f32 v34, v34, v72
  v_add_f32 v35, v35, v73
  v_add_f32 v36, v36, v74
  v_add_f32 v37, v37, v75
  v_add_f32 v34, v34, v76
  v_add_f32 v35, v35, v77
  v_add_f32 v36, v36, v78
  v_add_f32 v37, v37, v79
  v_add_f32 v34, v34, v80
  v_add_f32 v35, v35, v81
  v_add_f32 v36, v36, v82
  v_add_f32 v37, v37, v83
  v_add_f32 v34, v34, v84
  v_add_f32 v35, v35, v85
  v_add_f32 v36, v36, v86
  v_add_f32 v37, v37, v87
  v_add_f32 v34, v34, v88
  v_add_f32 v35, v35, v89
  v_add_f32 v36, v36, v90
  v_add_f32 v37, v37, v91
  v_add_f32 v34, v34, v92
  v_add_f32 v35, v35, v93
  v_add_f32 v36, v36, v94
  v_add_f32 v37, v37, v95
  v_lshlrev_b32 v64, 16, v176
  v_and_b32 v65, s73, v176
  v_lshlrev_b32 v66, 16, v177
  v_and_b32 v67, s73, v177
  v_lshlrev_b32 v68, 16, v178
  v_and_b32 v69, s73, v178
  v_lshlrev_b32 v70, 16, v179
  v_and_b32 v71, s73, v179
  v_lshlrev_b32 v72, 16, v180
  v_and_b32 v73, s73, v180
  v_lshlrev_b32 v74, 16, v181
  v_and_b32 v75, s73, v181
  v_lshlrev_b32 v76, 16, v182
  v_and_b32 v77, s73, v182
  v_lshlrev_b32 v78, 16, v183
  v_and_b32 v79, s73, v183
  v_lshlrev_b32 v80, 16, v184
  v_and_b32 v81, s73, v184
  v_lshlrev_b32 v82, 16, v185
  v_and_b32 v83, s73, v185
  v_lshlrev_b32 v84, 16, v186
  v_and_b32 v85, s73, v186
  v_lshlrev_b32 v86, 16, v187
  v_and_b32 v87, s73, v187
  v_lshlrev_b32 v88, 16, v188
  v_and_b32 v89, s73, v188
  v_lshlrev_b32 v90, 16, v189
  v_and_b32 v91, s73, v189
  v_lshlrev_b32 v92, 16, v190
  v_and_b32 v93, s73, v190
  v_lshlrev_b32 v94, 16, v191
  v_and_b32 v95, s73, v191
  v_fma_f32 v64, v64, s10, -v33
  v_fma_f32 v65, v65, s10, -v33
  v_fma_f32 v66, v66, s10, -v33
  v_fma_f32 v67, v67, s10, -v33
  v_fma_f32 v68, v68, s10, -v33
  v_fma_f32 v69, v69, s10, -v33
  v_fma_f32 v70, v70, s10, -v33
  v_fma_f32 v71, v71, s10, -v33
  v_fma_f32 v72, v72, s10, -v33
  v_fma_f32 v73, v73, s10, -v33
  v_fma_f32 v74, v74, s10, -v33
  v_fma_f32 v75, v75, s10, -v33
  v_fma_f32 v76, v76, s10, -v33
  v_fma_f32 v77, v77, s10, -v33
  v_fma_f32 v78, v78, s10, -v33
  v_fma_f32 v79, v79, s10, -v33
  v_fma_f32 v80, v80, s10, -v33
  v_fma_f32 v81, v81, s10, -v33
  v_fma_f32 v82, v82, s10, -v33
  v_fma_f32 v83, v83, s10, -v33
  v_fma_f32 v84, v84, s10, -v33
  v_fma_f32 v85, v85, s10, -v33
  v_fma_f32 v86, v86, s10, -v33
  v_fma_f32 v87, v87, s10, -v33
  v_fma_f32 v88, v88, s10, -v33
  v_fma_f32 v89, v89, s10, -v33
  v_fma_f32 v90, v90, s10, -v33
  v_fma_f32 v91, v91, s10, -v33
  v_fma_f32 v92, v92, s10, -v33
  v_fma_f32 v93, v93, s10, -v33
  v_fma_f32 v94, v94, s10, -v33
  v_fma_f32 v95, v95, s10, -v33
  v_exp_f32 v64, v64
  v_exp_f32 v65, v65
  v_exp_f32 v66, v66
  v_exp_f32 v67, v67
  v_exp_f32 v68, v68
  v_exp_f32 v69, v69
  v_exp_f32 v70, v70
  v_exp_f32 v71, v71
  v_exp_f32 v72, v72
  v_exp_f32 v73, v73
  v_exp_f32 v74, v74
  v_exp_f32 v75, v75
  v_exp_f32 v76, v76
  v_exp_f32 v77, v77
  v_exp_f32 v78, v78
  v_exp_f32 v79, v79
  v_exp_f32 v80, v80
  v_exp_f32 v81, v81
  v_exp_f32 v82, v82
  v_exp_f32 v83, v83
  v_exp_f32 v84, v84
  v_exp_f32 v85, v85
  v_exp_f32 v86, v86
  v_exp_f32 v87, v87
  v_exp_f32 v88, v88
  v_exp_f32 v89, v89
  v_exp_f32 v90, v90
  v_exp_f32 v91, v91
  v_exp_f32 v92, v92
  v_exp_f32 v93, v93
  v_exp_f32 v94, v94
  v_exp_f32 v95, v95
  v_add_f32 v34, v34, v64
  v_add_f32 v35, v35, v65
  v_add_f32 v36, v36, v66
  v_add_f32 v37, v37, v67
  v_add_f32 v34, v34, v68
  v_add_f32 v35, v35, v69
  v_add_f32 v36, v36, v70
  v_add_f32 v37, v37, v71
  v_add_f32 v34, v34, v72
  v_add_f32 v35, v35, v73
  v_add_f32 v36, v36, v74
  v_add_f32 v37, v37, v75
  v_add_f32 v34, v34, v76
  v_add_f32 v35, v35, v77
  v_add_f32 v36, v36, v78
  v_add_f32 v37, v37, v79
  v_add_f32 v34, v34, v80
  v_add_f32 v35, v35, v81
  v_add_f32 v36, v36, v82
  v_add_f32 v37, v37, v83
  v_add_f32 v34, v34, v84
  v_add_f32 v35, v35, v85
  v_add_f32 v36, v36, v86
  v_add_f32 v37, v37, v87
  v_add_f32 v34, v34, v88
  v_add_f32 v35, v35, v89
  v_add_f32 v36, v36, v90
  v_add_f32 v37, v37, v91
  v_add_f32 v34, v34, v92
  v_add_f32 v35, v35, v93
  v_add_f32 v36, v36, v94
  v_add_f32 v37, v37, v95
  v_add_f32 v34, v34, v35
  v_add_f32 v36, v36, v37
  v_add_f32 v34, v34, v36
  s_nop 1
  v_add_f32_dpp v34, v34, v34 row_ror:4 row_mask:0xf bank_mask:0xf
  s_nop 1
  v_add_f32_dpp v34, v34, v34 row_ror:8 row_mask:0xf bank_mask:0xf
  v_mov_b32 v35, v34
  s_nop 1
  v_permlane16_swap_b32 v34, v35
  v_add_f32 v34, v34, v35
  v_mov_b32 v35, v34
  s_nop 1
  v_permlane32_swap_b32 v34, v35
  v_add_f32 v34, v34, v35
  v_add_u32 v40, 0x80, v32
  v_bfi_b32 v40, v11, s75, v40
  v_add_u32 v41, 0x80, v34
  v_bfi_b32 v41, v11, s75, v41
  v_add_u32 v42, 0x80, v32
  v_bfi_b32 v42, v11, s75, v42
  v_add_u32 v43, 0x80, v34
  v_bfi_b32 v43, v11, s75, v43
  s_lshl_b32 s63, s2, 7
  s_add_u32 s63, s63, 0x180000
  s_mov_b64 exec, 0xff
  s_cmp_eq_u32 s55, 1
  s_cbranch_scc0 L_sls
  buffer_store_dwordx4 v[40:43], v13, s[16:19], s63 offen
  s_branch L_sds
L_sls:
  buffer_store_dwordx4 v[40:43], v13, s[16:19], s63 offen sc1
L_sds:
  s_mov_b64 exec, -1
  s_and_b32 s63, s2, 0xc7
  s_lshl_b32 s63, s63, 7
  s_add_u32 s63, s63, 0x180000
  s_cmp_eq_u32 s55, 1
  s_cbranch_scc0 L_noctlb
  s_lshl_b32 s64, s5, 7
  s_add_u32 s64, s64, 0x1a0000
  s_lshr_b32 s65, s2, 3
  s_lshl_b32 s65, s65, 2
  s_add_u32 s65, s65, s64
  v_and_b32 v124, 31, v0
  v_lshlrev_b32 v124, 2, v124
  s_mov_b32 s20, 48
  s_and_b32 s11, s75, 0xff
L_ctlb:
  s_mov_b32 s72, 0
L_wctlb:
  ds_read_b32 v30, v7 offset:2056
  s_add_u32 s72, s72, 1
  s_waitcnt lgkmcnt(0)
  v_cmp_le_u32 vcc, s20, v30
  s_cbranch_vccnz L_gctlb
  s_sleep 4
  s_cmp_lt_u32 s72, 0x400000
  s_cbranch_scc1 L_wctlb
L_gctlb:
  s_lshl_b32 s21, s20, 8
  s_or_b32 s21, s21, s11
  v_mov_b32 v125, s21
  buffer_load_dword v126, v124, s[16:19], s64 offen sc1
  buffer_store_dword v125, v7, s[16:19], s65 offen
  s_waitcnt vmcnt(1)
  v_and_b32 v127, 0xffff00ff, v126
  v_cmp_eq_u32 vcc, s11, v127
  v_cmp_le_u32 s[70:71], v125, v126
  s_and_b32 s21, vcc_lo, s70
  s_bcnt1_i32_b32 s21, s21
  s_cmp_ge_u32 s21, 22
  s_cselect_b32 s21, 0, 52
  v_mov_b32 v127, s21
  ds_write_b32 v7, v127 offset:2128
  s_add_u32 s20, s20, 6
  s_cmp_le_u32 s20, 48
  s_cbranch_scc1 L_ctlb
L_noctlb:
  s_mov_b32 s72, 0
L_wst:
  ds_read_b32 v30, v7 offset:2056
  s_add_u32 s72, s72, 1
  s_waitcnt lgkmcnt(0)
  v_cmp_le_u32 vcc, 56, v30
  s_cbranch_vccnz L_gst
  s_sleep 4
  s_cmp_lt_u32 s72, 0x400000
  s_cbranch_scc1 L_wst
L_gst:
  s_mov_b32 s72, 0
L_polls:
  buffer_load_dwordx2 v[44:45], v1, s[16:19], s63 offen sc1
L_pws:
  s_waitcnt vmcnt(0)
  v_xor_b32 v44, s75, v44
  v_xor_b32 v45, s75, v45
  v_or_b32 v30, v44, v45
  v_and_b32 v31, 0xff, v30
  v_cmp_ne_u32 vcc, 0, v31
  s_cbranch_vccz L_gots
  s_mov_b64 exec, vcc
  s_sleep 8
  s_add_u32 s72, s72, 1
  s_cmp_lt_u32 s72, 0x40000
  s_cbranch_scc1 L_polls
L_gots:
  s_mov_b64 exec, -1
  v_max_f32_dpp v46, v44, v44 row_ror:8 row_mask:0xf bank_mask:0xf
  v_mov_b32 v36, v46
  s_nop 1
  v_permlane16_swap_b32 v46, v36
  v_max_f32 v46, v46, v36
  v_mov_b32 v36, v46
  s_nop 1
  v_permlane32_swap_b32 v46, v36
  v_max_f32 v46, v46, v36
  v_sub_f32 v47, v44, v46
  v_sub_f32 v32, v32, v46
  v_mul_f32 v47, s10, v47
  v_mul_f32 v32, s10, v32
  v_exp_f32 v47, v47
  v_exp_f32 v32, v32
  v_mul_f32 v47, v47, v45
  s_nop 1
  v_add_f32_dpp v47, v47, v47 row_ror:8 row_mask:0xf bank_mask:0xf
  v_mov_b32 v36, v47
  s_nop 1
  v_permlane16_swap_b32 v47, v36
  v_add_f32 v47, v47, v36
  v_mov_b32 v36, v47
  s_nop 1
  v_permlane32_swap_b32 v47, v36
  v_add_f32 v47, v47, v36
  v_rcp_f32 v47, v47
  v_mov_b32 v33, 1
  v_lshlrev_b32 v30, 1, v8
  v_mul_f32 v32, v32, v47
  ds_write_b64 v30, v[32:33] offset:2096
  s_cmp_ge_u32 s54, 28
  s_cbranch_scc1 L_noffn
  s_mov_b32 s72, 0
L_wtrig:
  ds_read_b32 v30, v7 offset:2056
  s_add_u32 s72, s72, 1
  s_waitcnt lgkmcnt(0)
  v_cmp_le_u32 vcc, 68, v30
  s_cbranch_vccnz L_gtrig
  s_sleep 4
  s_cmp_lt_u32 s72, 0x400000
  s_cbranch_scc1 L_wtrig
L_gtrig:
  buffer_load_dwordx4 v120, s[24:27], s66 offen offset:0 nt lds
  buffer_load_dwordx4 v121, s[24:27], s66 offen offset:1024 nt lds
  buffer_load_dwordx4 v122, s[24:27], s66 offen offset:2048 nt lds
  buffer_load_dwordx4 v123, s[24:27], s66 offen offset:3072 nt lds
  s_add_u32 m0, m0, 4096
  s_nop 0
  buffer_load_dwordx4 v120, s[24:27], s67 offen offset:0 nt lds
  buffer_load_dwordx4 v121, s[24:27], s67 offen offset:1024 nt lds
  buffer_load_dwordx4 v122, s[24:27], s67 offen offset:2048 nt lds
  buffer_load_dwordx4 v123, s[24:27], s67 offen offset:3072 nt lds
  s_mov_b32 s72, 0
L_pollh:
  buffer_load_dwordx4 v[64:67], v12, s[16:19], s56 offen offset:0 sc1
  buffer_load_dwordx4 v[68:71], v12, s[16:19], s56 offen offset:16 sc1
  buffer_load_dwordx4 v[72:75], v12, s[16:19], s57 offen offset:0 sc1
  buffer_load_dwordx4 v[76:79], v12, s[16:19], s57 offen offset:16 sc1
  buffer_load_dwordx4 v[80:83], v12, s[16:19], s58 offen offset:0 sc1
  buffer_load_dwordx4 v[84:87], v12, s[16:19], s58 offen offset:16 sc1
  buffer_load_dwordx4 v[88:91], v12, s[16:19], s59 offen offset:0 sc1
  buffer_load_dwordx4 v[92:95], v12, s[16:19], s59 offen offset:16 sc1
L_pwh:
  s_waitcnt vmcnt(0)
  v_xor_b32 v64, s75, v64
  v_xor_b32 v65, s75, v65
  v_xor_b32 v66, s75, v66
  v_xor_b32 v67, s75, v67
  v_xor_b32 v68, s75, v68
  v_xor_b32 v69, s75, v69
  v_xor_b32 v70, s75, v70
  v_xor_b32 v71, s75, v71
  v_xor_b32 v72, s75, v72
  v_xor_b32 v73, s75, v73
  v_xor_b32 v74, s75, v74
  v_xor_b32 v75, s75, v75
  v_xor_b32 v76, s75, v76
  v_xor_b32 v77, s75, v77
  v_xor_b32 v78, s75, v78
  v_xor_b32 v79, s75, v79
  v_xor_b32 v80, s75, v80
  v_xor_b32 v81, s75, v81
  v_xor_b32 v82, s75, v82
  v_xor_b32 v83, s75, v83
  v_xor_b32 v84, s75, v84
  v_xor_b32 v85, s75, v85
  v_xor_b32 v86, s75, v86
  v_xor_b32 v87, s75, v87
  v_xor_b32 v88, s75, v88
  v_xor_b32 v89, s75, v89
  v_xor_b32 v90, s75, v90
  v_xor_b32 v91, s75, v91
  v_xor_b32 v92, s75, v92
  v_xor_b32 v93, s75, v93
  v_xor_b32 v94, s75, v94
  v_xor_b32 v95, s75, v95
  v_or3_b32 v30, v64, v65, v66
  v_or3_b32 v31, v67, v68, v69
  v_or3_b32 v30, v30, v70, v71
  v_or3_b32 v31, v31, v72, v73
  v_or3_b32 v30, v30, v74, v75
  v_or3_b32 v31, v31, v76, v77
  v_or3_b32 v30, v30, v78, v79
  v_or3_b32 v31, v31, v80, v81
  v_or3_b32 v30, v30, v82, v83
  v_or3_b32 v31, v31, v84, v85
  v_or3_b32 v30, v30, v86, v87
  v_or3_b32 v31, v31, v88, v89
  v_or3_b32 v30, v30, v90, v91
  v_or3_b32 v31, v31, v92, v93
  v_or3_b32 v30, v30, v94, v95
  v_or_b32 v30, v30, v31
  v_and_b32 v31, 0xff, v30
  v_cmp_ne_u32 vcc, 0, v31
  s_cbranch_vccz L_goth
  s_mov_b64 exec, vcc
  s_sleep 2
  s_add_u32 s72, s72, 1
  s_cmp_lt_u32 s72, 0x40000
  s_cbranch_scc1 L_pollh
L_goth:
  s_mov_b64 exec, -1
  ds_read_b64_tr_b16 v[128:129], v9 offset:36864
  ds_read_b64_tr_b16 v[130:131], v9 offset:37376
  ds_read_b64_tr_b16 v[132:133], v9 offset:36896
  ds_read_b64_tr_b16 v[134:135], v9 offset:37408
  ds_read_b64_tr_b16 v[136:137], v9 offset:36928
  ds_read_b64_tr_b16 v[138:139], v9 offset:37440
  ds_read_b64_tr_b16 v[140:141], v9 offset:36960
  ds_read_b64_tr_b16 v[142:143], v9 offset:37472
  ds_read_b64_tr_b16 v[144:145], v9 offset:40960
  ds_read_b64_tr_b16 v[146:147], v9 offset:41472
  ds_read_b64_tr_b16 v[148:149], v9 offset:40992
  ds_read_b64_tr_b16 v[150:151], v9 offset:41504
  ds_read_b64_tr_b16 v[152:153], v9 offset:41024
  ds_read_b64_tr_b16 v[154:155], v9 offset:41536
  ds_read_b64_tr_b16 v[156:157], v9 offset:41056
  ds_read_b64_tr_b16 v[158:159], v9 offset:41568
  v_pk_add_f32 v[64:65], v[64:65], v[72:73]
  v_pk_add_f32 v[80:81], v[80:81], v[88:89]
  v_pk_add_f32 v[66:67], v[66:67], v[74:75]
  v_pk_add_f32 v[82:83], v[82:83], v[90:91]
  v_pk_add_f32 v[68:69], v[68:69], v[76:77]
  v_pk_add_f32 v[84:85], v[84:85], v[92:93]
  v_pk_add_f32 v[70:71], v[70:71], v[78:79]
  v_pk_add_f32 v[86:87], v[86:87], v[94:95]
  v_pk_add_f32 v[64:65], v[64:65], v[80:81]
  v_pk_add_f32 v[66:67], v[66:67], v[82:83]
  v_pk_add_f32 v[68:69], v[68:69], v[84:85]
  v_pk_add_f32 v[70:71], v[70:71], v[86:87]
  s_nop 1
  v_add_f32_dpp v64, v64, v64 row_ror:8 row_mask:0xf bank_mask:0xf
  v_add_f32_dpp v65, v65, v65 row_ror:8 row_mask:0xf bank_mask:0xf
  v_add_f32_dpp v66, v66, v66 row_ror:8 row_mask:0xf bank_mask:0xf
  v_add_f32_dpp v67, v67, v67 row_ror:8 row_mask:0xf bank_mask:0xf
  v_add_f32_dpp v68, v68, v68 row_ror:8 row_mask:0xf bank_mask:0xf
  v_add_f32_dpp v69, v69, v69 row_ror:8 row_mask:0xf bank_mask:0xf
  v_add_f32_dpp v70, v70, v70 row_ror:8 row_mask:0xf bank_mask:0xf
  v_add_f32_dpp v71, v71, v71 row_ror:8 row_mask:0xf bank_mask:0xf
  v_cvt_pk_bf16_f32 v20, v64, v65
  v_cvt_pk_bf16_f32 v21, v66, v67
  v_cvt_pk_bf16_f32 v22, v68, v69
  v_cvt_pk_bf16_f32 v23, v70, v71
  v_lshlrev_b32 v64, 16, v20
  v_and_b32 v65, s73, v20
  v_lshlrev_b32 v66, 16, v21
  v_and_b32 v67, s73, v21
  v_lshlrev_b32 v68, 16, v22
  v_and_b32 v69, s73, v22
  v_lshlrev_b32 v70, 16, v23
  v_and_b32 v71, s73, v23
  v_lshlrev_b32 v24, 16, v16
  v_and_b32 v25, s73, v16
  v_add_f32 v64, v64, v24
  v_add_f32 v65, v65, v25
  v_lshlrev_b32 v24, 16, v17
  v_and_b32 v25, s73, v17
  v_add_f32 v66, v66, v24
  v_add_f32 v67, v67, v25
  v_lshlrev_b32 v24, 16, v18
  v_and_b32 v25, s73, v18
  v_add_f32 v68, v68, v24
  v_add_f32 v69, v69, v25
  v_lshlrev_b32 v24, 16, v19
  v_and_b32 v25, s73, v19
  v_add_f32 v70, v70, v24
  v_add_f32 v71, v71, v25
  v_cvt_pk_bf16_f32 v20, v64, v65
  v_cvt_pk_bf16_f32 v21, v66, v67
  v_cvt_pk_bf16_f32 v22, v68, v69
  v_cvt_pk_bf16_f32 v23, v70, v71
  v_lshlrev_b32 v64, 16, v20
  v_and_b32 v65, s73, v20
  v_lshlrev_b32 v66, 16, v21
  v_and_b32 v67, s73, v21
  v_lshlrev_b32 v68, 16, v22
  v_and_b32 v69, s73, v22
  v_lshlrev_b32 v70, 16, v23
  v_and_b32 v71, s73, v23
  v_max_f32 v64, 0, v64
  v_max_f32 v65, 0, v65
  v_max_f32 v66, 0, v66
  v_max_f32 v67, 0, v67
  v_max_f32 v68, 0, v68
  v_max_f32 v69, 0, v69
  v_max_f32 v70, 0, v70
  v_max_f32 v71, 0, v71
  v_mul_f32 v64, v64, v64
  v_mul_f32 v65, v65, v65
  v_mul_f32 v66, v66, v66
  v_mul_f32 v67, v67, v67
  v_mul_f32 v68, v68, v68
  v_mul_f32 v69, v69, v69
  v_mul_f32 v70, v70, v70
  v_mul_f32 v71, v71, v71
  v_cvt_pk_bf16_f32 v48, v64, v65
  v_cvt_pk_bf16_f32 v49, v66, v67
  v_cvt_pk_bf16_f32 v50, v68, v69
  v_cvt_pk_bf16_f32 v51, v70, v71
  s_nop 0
  v_mov_b32_dpp v52, v48 row_ror:4 row_mask:0xf bank_mask:0xf
  v_mov_b32_dpp v53, v49 row_ror:4 row_mask:0xf bank_mask:0xf
  v_mov_b32_dpp v54, v50 row_ror:4 row_mask:0xf bank_mask:0xf
  v_mov_b32_dpp v55, v51 row_ror:4 row_mask:0xf bank_mask:0xf
  s_waitcnt lgkmcnt(0)
  s_nop 0
  v_mfma_f32_16x16x32_bf16 v[32:35], v[48:51], v[128:131], 0
  v_mfma_f32_16x16x32_bf16 v[36:39], v[48:51], v[132:135], 0
  v_mfma_f32_16x16x32_bf16 v[40:43], v[48:51], v[136:139], 0
  v_mfma_f32_16x16x32_bf16 v[44:47], v[48:51], v[140:143], 0
  v_mfma_f32_16x16x32_bf16 v[32:35], v[52:55], v[144:147], v[32:35]
  v_mfma_f32_16x16x32_bf16 v[36:39], v[52:55], v[148:151], v[36:39]
  v_mfma_f32_16x16x32_bf16 v[40:43], v[52:55], v[152:155], v[40:43]
  v_mfma_f32_16x16x32_bf16 v[44:47], v[52:55], v[156:159], v[44:47]
  s_nop 7
  v_add_u32 v64, 0x80, v32
  v_bfi_b32 v64, v11, s75, v64
  v_add_u32 v65, 0x80, v36
  v_bfi_b32 v65, v11, s75, v65
  v_add_u32 v66, 0x80, v40
  v_bfi_b32 v66, v11, s75, v66
  v_add_u32 v67, 0x80, v44
  v_bfi_b32 v67, v11, s75, v67
  v_add_u32 v68, 0x80, v33
  v_bfi_b32 v68, v11, s75, v68
  v_add_u32 v69, 0x80, v37
  v_bfi_b32 v69, v11, s75, v69
  v_add_u32 v70, 0x80, v41
  v_bfi_b32 v70, v11, s75, v70
  v_add_u32 v71, 0x80, v45
  v_bfi_b32 v71, v11, s75, v71
  v_add_u32 v72, 0x80, v34
  v_bfi_b32 v72, v11, s75, v72
  v_add_u32 v73, 0x80, v38
  v_bfi_b32 v73, v11, s75, v73
  v_add_u32 v74, 0x80, v42
  v_bfi_b32 v74, v11, s75, v74
  v_add_u32 v75, 0x80, v46
  v_bfi_b32 v75, v11, s75, v75
  v_add_u32 v76, 0x80, v35
  v_bfi_b32 v76, v11, s75, v76
  v_add_u32 v77, 0x80, v39
  v_bfi_b32 v77, v11, s75, v77
  v_add_u32 v78, 0x80, v43
  v_bfi_b32 v78, v11, s75, v78
  v_add_u32 v79, 0x80, v47
  v_bfi_b32 v79, v11, s75, v79
  s_mov_b64 exec, 0xffff
  buffer_store_dwordx4 v[64:67], v13, s[16:19], s62 offen offset:0 sc1
  buffer_store_dwordx4 v[68:71], v13, s[16:19], s62 offen offset:256 sc1
  buffer_store_dwordx4 v[72:75], v13, s[16:19], s62 offen offset:512 sc1
  buffer_store_dwordx4 v[76:79], v13, s[16:19], s62 offen offset:768 sc1
  s_mov_b64 exec, -1
L_noffn:
  v_bfe_u32 v14, v0, 1, 3
  v_lshlrev_b32 v14, 10, v14
  v_and_b32 v12, 1, v0
  v_lshl_add_u32 v14, v12, 4, v14
  v_lshl_add_u32 v12, v5, 14, v14
  v_lshl_add_u32 v14, v5, 16, v14
  s_lshl_b32 s65, s4, 8
  s_lshl_b32 s64, s6, 5
  s_add_u32 s65, s65, s64
  s_lshr_b32 s63, s5, 1
  s_lshl_b32 s63, s63, 16
  s_and_b32 s64, s5, 1
  s_lshl_b32 s64, s64, 13
  s_add_u32 s63, s63, s64
  s_add_u32 s63, s63, s65
  s_add_u32 s63, s63, 0x80000
  s_lshl_b32 s64, s5, 13
  s_add_u32 s64, s64, s65
  s_add_u32 s64, s64, 0xc0000
  v_mov_b32 v32, 0
  v_mov_b32 v33, 0
  v_mov_b32 v34, 0
  v_mov_b32 v35, 0
  s_mov_b32 s72, 0
L_wy:
  ds_read_b32 v30, v7 offset:2060
  s_add_u32 s72, s72, 1
  s_waitcnt lgkmcnt(0)
  v_cmp_le_u32 vcc, 768, v30
  s_cbranch_vccnz L_gy
  s_sleep 1
  s_cmp_lt_u32 s72, 0x400000
  s_cbranch_scc1 L_wy
L_gy:
  s_mov_b32 s70, -1
  s_mov_b32 s71, 0x00ffffff
  s_mov_b64 exec, s[70:71]
  s_mov_b32 s72, 0
L_pollz:
  buffer_load_dwordx4 v[32:35], v12, s[16:19], s63 offen sc1
L_pwz:
  s_waitcnt vmcnt(0)
  v_xor_b32 v32, s75, v32
  v_xor_b32 v33, s75, v33
  v_xor_b32 v34, s75, v34
  v_xor_b32 v35, s75, v35
  v_or3_b32 v30, v32, v33, v34
  v_or_b32 v30, v30, v35
  v_and_b32 v31, 0xff, v30
  v_cmp_ne_u32 vcc, 0, v31
  s_cbranch_vccz L_gotz
  s_mov_b64 exec, vcc
  s_add_u32 s72, s72, 1
  s_cmp_lt_u32 s72, 0x40000
  s_cbranch_scc1 L_pollz
L_gotz:
  s_mov_b64 exec, -1
  s_cmp_lg_u32 s2, 0
  s_cbranch_scc1 L_noep
  s_mov_b32 s63, 0x1c0000
  v_lshlrev_b32 v30, 2, v0
  buffer_store_dword v6, v30, s[16:19], s63 offen sc1
L_noep:
  buffer_load_dwordx4 v[64:67], v14, s[16:19], s64 offen sc1
  v_permlane32_swap_b32 v32, v34
  v_permlane32_swap_b32 v33, v35
  v_add_f32 v32, v32, v34
  v_add_f32 v33, v33, v35
  s_nop 1
  v_permlane16_swap_b32 v32, v33
  v_add_f32 v32, v32, v33
  s_nop 1
  v_add_f32_dpp v32, v32, v32 row_ror:8 row_mask:0xf bank_mask:0xf
  s_nop 1
  v_add_f32_dpp v32, v32, v32 row_ror:4 row_mask:0xf bank_mask:0xf
  s_nop 1
  v_add_f32_dpp v32, v32, v32 row_ror:2 row_mask:0xf bank_mask:0xf
  v_cvt_pk_bf16_f32 v32, v32, v32
  v_lshlrev_b32 v32, 16, v32
  v_lshlrev_b32 v29, 16, v29
  v_add_f32 v32, v32, v29
  v_cvt_pk_bf16_f32 v32, v32, v32
  v_lshlrev_b32 v32, 16, v32
  v_mul_f32 v30, 0xbfb8aa3b, v32
  v_exp_f32 v30, v30
  s_nop 0
  v_add_f32 v30, 1.0, v30
  v_rcp_f32 v30, v30
  s_nop 0
  v_mul_f32 v32, v32, v30
  v_cvt_pk_bf16_f32 v32, v32, v32
  v_lshlrev_b32 v32, 16, v32
  v_lshlrev_b32 v33, 16, v28
  s_mov_b32 s70, 0x00030003
  s_mov_b32 s71, 0x00030003
  buffer_load_dwordx4 v[68:71], v14, s[16:19], s64 offen sc1
  s_mov_b32 s72, 0
L_polly:
  s_waitcnt vmcnt(1)
  v_xor_b32 v64, s75, v64
  v_xor_b32 v65, s75, v65
  v_xor_b32 v66, s75, v66
  v_xor_b32 v67, s75, v67
  v_or3_b32 v30, v64, v65, v66
  v_or_b32 v30, v30, v67
  v_and_b32 v31, 0xff, v30
  v_cmp_ne_u32 vcc, 0, v31
  v_mov_b32 v36, v64
  v_mov_b32 v37, v65
  v_mov_b32 v38, v66
  v_mov_b32 v39, v67
  s_cbranch_vccz L_goty
  s_mov_b64 exec, vcc
  buffer_load_dwordx4 v[64:67], v14, s[16:19], s64 offen sc1
  s_waitcnt vmcnt(1)
  v_xor_b32 v68, s75, v68
  v_xor_b32 v69, s75, v69
  v_xor_b32 v70, s75, v70
  v_xor_b32 v71, s75, v71
  v_or3_b32 v30, v68, v69, v70
  v_or_b32 v30, v30, v71
  v_and_b32 v31, 0xff, v30
  v_cmp_ne_u32 vcc, 0, v31
  v_mov_b32 v36, v68
  v_mov_b32 v37, v69
  v_mov_b32 v38, v70
  v_mov_b32 v39, v71
  s_cbranch_vccz L_goty
  s_mov_b64 exec, vcc
  buffer_load_dwordx4 v[68:71], v14, s[16:19], s64 offen sc1
  s_add_u32 s72, s72, 1
  s_cmp_lt_u32 s72, 0x40000
  s_cbranch_scc1 L_polly
L_goty:
  s_mov_b64 exec, -1
  v_permlane32_swap_b32 v36, v38
  v_permlane32_swap_b32 v37, v39
  v_add_f32 v36, v36, v38
  v_add_f32 v37, v37, v39
  s_nop 1
  v_permlane16_swap_b32 v36, v37
  v_add_f32 v36, v36, v37
  s_nop 1
  v_add_f32_dpp v36, v36, v36 row_ror:8 row_mask:0xf bank_mask:0xf
  s_nop 1
  v_add_f32_dpp v36, v36, v36 row_ror:4 row_mask:0xf bank_mask:0xf
  s_nop 1
  v_add_f32_dpp v36, v36, v36 row_ror:2 row_mask:0xf bank_mask:0xf
  v_cvt_pk_bf16_f32 v36, v36, v36
  v_lshlrev_b32 v36, 16, v36
  v_mul_f32 v36, v36, v32
  v_cvt_pk_bf16_f32 v36, v36, v36
  v_lshlrev_b32 v36, 16, v36
  v_add_f32 v36, v36, v33
  v_cvt_pk_bf16_f32 v36, v36, v36
  s_mov_b64 exec, s[70:71]
  buffer_store_short v36, v15, s[48:51], s53 offen
L_fin:
L_end:
  s_endpgm
.section .rodata,"a"
.p2align 6
.amdhsa_kernel recurrent_scan__gqa_block_cached__dense_activation_squared_relu__decode_kernel
  .amdhsa_next_free_vgpr 256
  .amdhsa_next_free_sgpr 102
  .amdhsa_accum_offset 256
  .amdhsa_group_segment_fixed_size 0
  .amdhsa_kernarg_size 104
  .amdhsa_user_sgpr_count 2
  .amdhsa_user_sgpr_kernarg_segment_ptr 1
  .amdhsa_system_sgpr_workgroup_id_x 1
  .amdhsa_float_denorm_mode_32 3
.end_amdhsa_kernel
```
